```python
import torch

def _softmax(x, axis=-1):
    return torch.softmax(x, dim=axis)
def _gelu(x):
    return torch.nn.functional.gelu(x, approximate="tanh")
def _silu(x):
    return torch.nn.functional.silu(x)
def _sigmoid(x):
    return torch.sigmoid(x)
def _layernorm(x, axis=-1, eps=1e-5):
    m = x.mean(dim=axis, keepdim=True)
    v = x.var(dim=axis, keepdim=True, unbiased=False)
    return (x - m) / torch.sqrt(v + eps)
def _scatter_add(tgt, idx, src, axis=0):
    return tgt.clone().index_add_(axis, idx, src)
def _segment_sum(src, seg, n):
    out = torch.zeros((n,) + src.shape[1:], dtype=src.dtype)
    return out.index_add_(0, seg, src)
def _pad(x, pw):
    flat = tuple(v for pair in reversed(pw) for v in pair)
    return torch.nn.functional.pad(x, flat)

kernel_name = 'standalone__low_rank_proj_linformer__prompt'

def setup_inputs():

    _w = (lambda a: (lambda t: t.to(torch.bfloat16) if t.is_floating_point() else t)(torch.as_tensor(a)))
    B, H, Sq, Skv, Dh, R = 1, 32, 2048, 2048, 192, 64
    return {
        "q": _w((lambda *s: torch.randn(*s, dtype=torch.bfloat16) * 0.8)(B, H, Sq, Dh)),
        "k": _w((lambda *s: torch.randn(*s, dtype=torch.bfloat16) * 0.8)(B, H, Skv, Dh)),
        "v": _w((lambda *s: torch.randn(*s, dtype=torch.bfloat16) * 0.05)(B, H, Skv, Dh)),
        "e_proj": _w((lambda *s: torch.randn(*s, dtype=torch.bfloat16) * 0.8)(R, Skv) * (Skv ** -0.5)),
        "f_proj": _w((lambda *s: torch.randn(*s, dtype=torch.bfloat16) * 0.05)(R, Skv) * (Skv ** -0.5)),
    }

def reference(q, k, v, e_proj, f_proj):
    B, H, Sq, Dh = q.shape
    kp = torch.einsum("rn,bhnd->bhrd", e_proj, k)
    vp = torch.einsum("rn,bhnd->bhrd", f_proj, v)
    scores = torch.einsum("bhqd,bhrd->bhqr", q, kp) * (Dh ** -0.5)
    p = _softmax(scores, axis=-1)
    o = torch.einsum("bhqr,bhrd->bhqd", p, vp)
    return o
```

```asm
; @launch grid=(256,1,1) block=(640,1,1) lds=163840
.amdgcn_target "amdgcn-amd-amdhsa--gfx950"
.text
.globl standalone__low_rank_proj_linformer__prompt_kernel
.p2align 8
.type standalone__low_rank_proj_linformer__prompt_kernel,@function
standalone__low_rank_proj_linformer__prompt_kernel:
    s_cmp_ge_u32 s2, 256
    s_cbranch_scc1 L_END
    s_load_dwordx16 s[4:19], s[0:1], 0
    v_and_b32 v1, 63, v0
    v_lshrrev_b32 v132, 6, v0
    s_and_b32 s45, s2, 31
    v_readfirstlane_b32 s44, v132
    s_lshr_b32 s46, s2, 5
    v_mul_u32_u24 v134, 171, v1
    v_lshlrev_b32 v133, 4, v1
    s_mul_i32 s49, s45, 786432
    s_cmp_ge_u32 s44, 8
    s_cbranch_scc1 L_HELP
L_COMP:
    s_movk_i32 s52, 192
    s_lshr_b32 s47, s46, 2
    s_bfe_u32 s48, s46, 0x10001
    s_and_b32 s92, s46, 1
    v_lshrrev_b32 v135, 11, v134
    v_mad_u32_u24 v32, v135, s52, v133
    v_add_u32 v135, 10944, v134
    v_lshrrev_b32 v135, 11, v135
    v_and_b32 v136, 32, v1
    v_xor_b32 v136, v136, v133
    v_mad_u32_u24 v33, v135, s52, v136
    v_add_u32 v135, 21888, v134
    v_lshrrev_b32 v135, 11, v135
    v_xor_b32 v136, 32, v133
    v_mad_u32_u24 v34, v135, s52, v136
    s_mul_i32 s62, s44, 3072
    s_mul_i32 s51, s92, 192
    s_lshl1_add_u32 s51, s62, s51
    s_mul_i32 s50, s48, 393216
    s_add_u32 s50, s50, s49
    s_add_u32 s50, s50, s51
    s_sub_u32 s22, 393216, s51
    s_mov_b32 s23, 0x00020000
    v_lshrrev_b32 v132, 3, v1
    s_lshl_b32 s51, s44, 3
    v_add_u32 v134, s51, v132
    v_bfe_u32 v135, v134, 1, 3
    v_and_b32 v136, 7, v1
    v_xor_b32 v135, v135, v136
    v_lshlrev_b32 v135, 4, v135
    v_lshl_add_u32 v35, v134, 12, v135
    s_lshl_b32 s63, s44, 10
    s_add_u32 s63, s63, 98304
    s_lshl_b32 s51, s48, 11
    s_sub_u32 s26, 262144, s51
    s_mov_b32 s27, 0x00020000
    s_cmp_eq_u32 s47, 0
    s_waitcnt lgkmcnt(0)
    s_cselect_b32 s20, s6, s8
    s_cselect_b32 s21, s7, s9
    s_cselect_b32 s24, s10, s12
    s_cselect_b32 s25, s11, s13
    s_add_u32 s20, s20, s50
    s_addc_u32 s21, s21, 0
    s_add_u32 s24, s24, s51
    s_addc_u32 s25, s25, 0
    s_add_u32 m0, s62, 0
    s_mov_b32 s52, 0
    buffer_load_dwordx4 v32, s[20:23], s52 offen offset:0 nt lds
    buffer_load_dwordx4 v33, s[20:23], s52 offen offset:1024 nt lds
    buffer_load_dwordx4 v34, s[20:23], s52 offen offset:2048 nt lds
    s_add_u32 m0, s63, 0
    s_movk_i32 s52, 0
    buffer_load_dwordx4 v35, s[24:27], s52 offen lds
    s_add_u32 m0, s63, 8192
    s_movk_i32 s52, 128
    buffer_load_dwordx4 v35, s[24:27], s52 offen lds
    s_barrier
    s_add_u32 m0, s62, 24576
    s_mov_b32 s52, 49152
    buffer_load_dwordx4 v32, s[20:23], s52 offen offset:0 nt lds
    buffer_load_dwordx4 v33, s[20:23], s52 offen offset:1024 nt lds
    buffer_load_dwordx4 v34, s[20:23], s52 offen offset:2048 nt lds
    s_add_u32 m0, s63, 16384
    s_movk_i32 s52, 256
    buffer_load_dwordx4 v35, s[24:27], s52 offen lds
    s_add_u32 m0, s63, 24576
    s_movk_i32 s52, 384
    buffer_load_dwordx4 v35, s[24:27], s52 offen lds
    s_barrier
    s_add_u32 m0, s62, 49152
    s_mov_b32 s52, 98304
    buffer_load_dwordx4 v32, s[20:23], s52 offen offset:0 nt lds
    buffer_load_dwordx4 v33, s[20:23], s52 offen offset:1024 nt lds
    buffer_load_dwordx4 v34, s[20:23], s52 offen offset:2048 nt lds
    s_add_u32 m0, s63, 32768
    s_movk_i32 s52, 512
    buffer_load_dwordx4 v35, s[24:27], s52 offen lds
    s_add_u32 m0, s63, 40960
    s_movk_i32 s52, 640
    buffer_load_dwordx4 v35, s[24:27], s52 offen lds
    s_barrier
    s_add_u32 m0, s62, 73728
    s_mov_b32 s52, 147456
    buffer_load_dwordx4 v32, s[20:23], s52 offen offset:0 nt lds
    buffer_load_dwordx4 v33, s[20:23], s52 offen offset:1024 nt lds
    buffer_load_dwordx4 v34, s[20:23], s52 offen offset:2048 nt lds
    s_and_b32 s53, s44, 3
    s_lshr_b32 s54, s44, 2
    s_mul_i32 s50, s46, 98304
    s_add_u32 s50, s50, s49
    s_add_u32 s32, s14, s50
    s_addc_u32 s33, s15, 0
    s_mov_b32 s34, 98304
    s_mov_b32 s35, 0x00020000
    s_mul_i32 s50, s45, 98304
    s_add_u32 s36, s18, s50
    s_addc_u32 s37, s19, 0
    s_mov_b32 s38, 98304
    s_mov_b32 s39, 0x00020000
    s_mul_i32 s50, s45, 4352
    s_add_u32 s50, s50, 0x800000
    s_add_u32 s96, s18, s50
    s_addc_u32 s97, s19, 0
    s_mov_b32 s98, 32
    s_mov_b32 s99, 0x00020000
    s_mov_b32 s55, 0x00003f80
    s_mov_b32 s56, 0x3f800000
    s_mov_b32 s57, 0x3dd53b95
    s_mov_b32 s58, 0
    s_mov_b32 s59, 3072
    s_mov_b32 s60, 6144
    s_mov_b32 s61, 9216
    v_mov_b32 v2, 147456
    v_mov_b32 v3, 1
    s_lshl_b32 s50, s46, 2
    v_mov_b32 v45, s50
    v_lshrrev_b32 v134, 4, v1
    v_and_b32 v135, 15, v1
    v_lshrrev_b32 v137, 1, v135
    v_xor_b32 v137, v137, v134
    v_lshlrev_b32 v137, 4, v137
    v_lshl_add_u32 v137, v135, 7, v137
    s_lshl_b32 s50, s53, 11
    s_add_u32 s50, s50, 98304
    v_add_u32 v36, s50, v137
    v_xor_b32 v37, 64, v36
    v_bfe_u32 v137, v1, 2, 2
    v_lshl_add_u32 v137, v134, 3, v137
    v_mul_u32_u24 v137, 192, v137
    v_and_b32 v138, 3, v1
    v_lshl_add_u32 v137, v138, 3, v137
    v_bfe_u32 v138, v1, 4, 1
    v_lshlrev_b32 v138, 5, v138
    s_lshl_b32 s50, s54, 7
    v_xad_u32 v38, v138, s50, v137
    v_xor_b32 v39, 32, v38
    s_lshl_b32 s50, s54, 5
    s_add_u32 s50, s50, 64
    v_xad_u32 v40, v138, s50, v137
    v_add_u32 v41, 49152, v38
    v_add_u32 v42, 49152, v39
    v_add_u32 v43, 49152, v40
    s_mul_i32 s49, s46, 12288
    s_lshl_b32 s51, s54, 13
    s_cmp_eq_u32 s47, 0
    s_cbranch_scc0 L_PO_V
    v_lshlrev_b32 v137, 4, v135
    v_lshl_add_u32 v137, v138, 6, v137
    v_lshrrev_b32 v138, 5, v1
    v_lshl_add_u32 v44, v138, 9, v137
    s_lshr_b32 s50, s53, 1
    s_lshl_b32 s50, s50, 10
    s_add_u32 s49, s49, s50
    s_and_b32 s50, s53, 1
    s_lshl_b32 s50, s50, 8
    s_add_u32 s49, s49, s50
    s_add_u32 s4, s49, s51
    s_lshl_b32 s50, s54, 11
    s_add_u32 s50, s50, 4096
    s_add_u32 s5, s49, s50
    s_mov_b32 s94, 0xffff
    s_mov_b32 s95, 0xffff
    s_branch L_PO_DONE
L_PO_V:
    v_and_b32 v137, 3, v1
    v_bfe_u32 v136, v1, 2, 1
    v_lshl_or_b32 v137, v136, 3, v137
    v_bfe_u32 v136, v1, 3, 1
    v_lshl_or_b32 v137, v136, 2, v137
    v_or_b32 v137, v137, v138
    v_lshlrev_b32 v137, 4, v137
    v_lshrrev_b32 v138, 5, v1
    v_lshl_add_u32 v44, v138, 8, v137
    s_lshl_b32 s50, s53, 10
    s_add_u32 s49, s49, s50
    s_add_u32 s4, s49, s51
    s_lshl_b32 s50, s54, 8
    s_add_u32 s50, s50, 4096
    s_add_u32 s5, s49, s50
    s_mov_b32 s94, -1
    s_mov_b32 s95, 0
L_PO_DONE:
    v_lshlrev_b32 v6, 4, v1
    s_mul_i32 s50, s54, 24576
    s_lshl1_add_u32 s51, s62, 98304
    s_lshl1_add_u32 s50, s62, s50
    v_add_u32 v4, s50, v6
    v_add_u32 v5, s51, v6
    v_add_u32 v6, 98304, v6
    s_bfe_u32 s11, s44, 0x10001
    s_lshl2_add_u32 s11, s54, s11
    s_lshl3_add_u32 s50, s54, 147472
    v_mov_b32 v28, s50
    s_mul_i32 s50, s44, 12288
    v_and_b32 v135, 31, v1
    v_lshrrev_b32 v134, 5, v1
    v_mul_u32_u24 v137, 3, v135
    v_add_u32 v138, 0, v137
    v_bfe_u32 v136, v138, 1, 3
    v_xor_b32 v136, v136, v134
    v_lshlrev_b32 v136, 4, v136
    v_lshl_add_u32 v138, v138, 7, s50
    v_add_u32 v16, v136, v138
    v_xad_u32 v17, v136, 32, v138
    v_xad_u32 v18, v136, 64, v138
    v_xor_b32 v133, 96, v136
    v_add_u32 v19, v133, v138
    v_add_u32 v138, 1, v137
    v_bfe_u32 v136, v138, 1, 3
    v_xor_b32 v136, v136, v134
    v_lshlrev_b32 v136, 4, v136
    v_lshl_add_u32 v138, v138, 7, s50
    v_add_u32 v20, v136, v138
    v_xad_u32 v21, v136, 32, v138
    v_xad_u32 v22, v136, 64, v138
    v_xor_b32 v133, 96, v136
    v_add_u32 v23, v133, v138
    v_add_u32 v138, 2, v137
    v_bfe_u32 v136, v138, 1, 3
    v_xor_b32 v136, v136, v134
    v_lshlrev_b32 v136, 4, v136
    v_lshl_add_u32 v138, v138, 7, s50
    v_add_u32 v24, v136, v138
    v_xad_u32 v25, v136, 32, v138
    v_xad_u32 v26, v136, 64, v138
    v_xor_b32 v133, 96, v136
    v_add_u32 v27, v133, v138
    v_and_b32 v136, 7, v135
    v_xor_b32 v136, v136, v134
    v_lshlrev_b32 v136, 4, v136
    v_lshl_add_u32 v138, v137, 7, s50
    v_add_u32 v9, v136, v138
    v_xad_u32 v10, v136, 32, v138
    v_xad_u32 v11, v136, 64, v138
    v_xor_b32 v133, 96, v136
    v_add_u32 v12, v133, v138
    v_lshrrev_b32 v132, 3, v1
    v_and_b32 v136, 7, v1
    v_mul_u32_u24 v137, 384, v132
    v_add_u32 v137, s50, v137
    v_lshl_add_u32 v8, v136, 4, v137
    v_xor_b32 v136, v136, v132
    v_lshl_add_u32 v7, v136, 4, v137
    s_mul_i32 s93, s44, 12
    s_add_u32 s93, s93, 12
    s_mov_b32 s64, 0
    s_mov_b32 s7, 0
    s_cmp_eq_u32 s47, 0
    s_cbranch_scc0 L_P1_V
    s_waitcnt vmcnt(13)
    s_barrier
    ds_read_b128 v[60:63], v36 offset:0
    ds_read_b64_tr_b16 v[76:77], v38 offset:0
    ds_read_b64_tr_b16 v[78:79], v38 offset:768
    ds_read_b64_tr_b16 v[80:81], v39 offset:0
    ds_read_b64_tr_b16 v[82:83], v39 offset:768
    ds_read_b64_tr_b16 v[84:85], v40 offset:0
    ds_read_b64_tr_b16 v[86:87], v40 offset:768
    ds_read_b128 v[64:67], v37 offset:0
    ds_read_b64_tr_b16 v[88:89], v38 offset:6144
    ds_read_b64_tr_b16 v[90:91], v38 offset:6912
    ds_read_b64_tr_b16 v[92:93], v39 offset:6144
    ds_read_b64_tr_b16 v[94:95], v39 offset:6912
    ds_read_b64_tr_b16 v[96:97], v40 offset:6144
    ds_read_b64_tr_b16 v[98:99], v40 offset:6912
    s_waitcnt lgkmcnt(11)
    v_mfma_f32_16x16x32_bf16 v[48:51], v[76:79], v[60:63], 0
    s_waitcnt lgkmcnt(9)
    v_mfma_f32_16x16x32_bf16 v[52:55], v[80:83], v[60:63], 0
    s_waitcnt lgkmcnt(7)
    v_mfma_f32_16x16x32_bf16 v[56:59], v[84:87], v[60:63], 0
    ds_read_b128 v[68:71], v36 offset:8192
    ds_read_b64_tr_b16 v[100:101], v38 offset:12288
    ds_read_b64_tr_b16 v[102:103], v38 offset:13056
    ds_read_b64_tr_b16 v[104:105], v39 offset:12288
    ds_read_b64_tr_b16 v[106:107], v39 offset:13056
    ds_read_b64_tr_b16 v[108:109], v40 offset:12288
    ds_read_b64_tr_b16 v[110:111], v40 offset:13056
    s_waitcnt lgkmcnt(11)
    v_mfma_f32_16x16x32_bf16 v[48:51], v[88:91], v[64:67], v[48:51]
    s_waitcnt lgkmcnt(9)
    v_mfma_f32_16x16x32_bf16 v[52:55], v[92:95], v[64:67], v[52:55]
    s_waitcnt lgkmcnt(7)
    v_mfma_f32_16x16x32_bf16 v[56:59], v[96:99], v[64:67], v[56:59]
    ds_read_b128 v[72:75], v37 offset:8192
    ds_read_b64_tr_b16 v[112:113], v38 offset:18432
    ds_read_b64_tr_b16 v[114:115], v38 offset:19200
    ds_read_b64_tr_b16 v[116:117], v39 offset:18432
    ds_read_b64_tr_b16 v[118:119], v39 offset:19200
    ds_read_b64_tr_b16 v[120:121], v40 offset:18432
    ds_read_b64_tr_b16 v[122:123], v40 offset:19200
    s_waitcnt lgkmcnt(11)
    v_mfma_f32_16x16x32_bf16 v[48:51], v[100:103], v[68:71], v[48:51]
    s_waitcnt lgkmcnt(9)
    v_mfma_f32_16x16x32_bf16 v[52:55], v[104:107], v[68:71], v[52:55]
    s_waitcnt lgkmcnt(7)
    v_mfma_f32_16x16x32_bf16 v[56:59], v[108:111], v[68:71], v[56:59]
    s_waitcnt lgkmcnt(4)
    v_mfma_f32_16x16x32_bf16 v[48:51], v[112:115], v[72:75], v[48:51]
    s_waitcnt lgkmcnt(2)
    v_mfma_f32_16x16x32_bf16 v[52:55], v[116:119], v[72:75], v[52:55]
    s_waitcnt lgkmcnt(0)
    v_mfma_f32_16x16x32_bf16 v[56:59], v[120:123], v[72:75], v[56:59]
    s_waitcnt vmcnt(8)
    s_barrier
    s_add_u32 m0, s63, 0
    s_movk_i32 s52, 768
    buffer_load_dwordx4 v35, s[24:27], s52 offen lds
    s_add_u32 m0, s63, 8192
    s_movk_i32 s52, 896
    buffer_load_dwordx4 v35, s[24:27], s52 offen lds
    s_add_u32 m0, s62, 0
    s_mov_b32 s52, 196608
    buffer_load_dwordx4 v32, s[20:23], s52 offen offset:0 nt lds
    buffer_load_dwordx4 v33, s[20:23], s52 offen offset:1024 nt lds
    buffer_load_dwordx4 v34, s[20:23], s52 offen offset:2048 nt lds
    ds_read_b128 v[60:63], v36 offset:16384
    ds_read_b64_tr_b16 v[76:77], v38 offset:24576
    ds_read_b64_tr_b16 v[78:79], v38 offset:25344
    ds_read_b64_tr_b16 v[80:81], v39 offset:24576
    ds_read_b64_tr_b16 v[82:83], v39 offset:25344
    ds_read_b64_tr_b16 v[84:85], v40 offset:24576
    ds_read_b64_tr_b16 v[86:87], v40 offset:25344
    ds_read_b128 v[64:67], v37 offset:16384
    ds_read_b64_tr_b16 v[88:89], v38 offset:30720
    ds_read_b64_tr_b16 v[90:91], v38 offset:31488
    ds_read_b64_tr_b16 v[92:93], v39 offset:30720
    ds_read_b64_tr_b16 v[94:95], v39 offset:31488
    ds_read_b64_tr_b16 v[96:97], v40 offset:30720
    ds_read_b64_tr_b16 v[98:99], v40 offset:31488
    s_waitcnt lgkmcnt(11)
    v_mfma_f32_16x16x32_bf16 v[48:51], v[76:79], v[60:63], v[48:51]
    s_waitcnt lgkmcnt(9)
    v_mfma_f32_16x16x32_bf16 v[52:55], v[80:83], v[60:63], v[52:55]
    s_waitcnt lgkmcnt(7)
    v_mfma_f32_16x16x32_bf16 v[56:59], v[84:87], v[60:63], v[56:59]
    ds_read_b128 v[68:71], v36 offset:24576
    ds_read_b64_tr_b16 v[100:101], v38 offset:36864
    ds_read_b64_tr_b16 v[102:103], v38 offset:37632
    ds_read_b64_tr_b16 v[104:105], v39 offset:36864
    ds_read_b64_tr_b16 v[106:107], v39 offset:37632
    ds_read_b64_tr_b16 v[108:109], v40 offset:36864
    ds_read_b64_tr_b16 v[110:111], v40 offset:37632
    s_waitcnt lgkmcnt(11)
    v_mfma_f32_16x16x32_bf16 v[48:51], v[88:91], v[64:67], v[48:51]
    s_waitcnt lgkmcnt(9)
    v_mfma_f32_16x16x32_bf16 v[52:55], v[92:95], v[64:67], v[52:55]
    s_waitcnt lgkmcnt(7)
    v_mfma_f32_16x16x32_bf16 v[56:59], v[96:99], v[64:67], v[56:59]
    ds_read_b128 v[72:75], v37 offset:24576
    ds_read_b64_tr_b16 v[112:113], v38 offset:43008
    ds_read_b64_tr_b16 v[114:115], v38 offset:43776
    ds_read_b64_tr_b16 v[116:117], v39 offset:43008
    ds_read_b64_tr_b16 v[118:119], v39 offset:43776
    ds_read_b64_tr_b16 v[120:121], v40 offset:43008
    ds_read_b64_tr_b16 v[122:123], v40 offset:43776
    s_waitcnt lgkmcnt(11)
    v_mfma_f32_16x16x32_bf16 v[48:51], v[100:103], v[68:71], v[48:51]
    s_waitcnt lgkmcnt(9)
    v_mfma_f32_16x16x32_bf16 v[52:55], v[104:107], v[68:71], v[52:55]
    s_waitcnt lgkmcnt(7)
    v_mfma_f32_16x16x32_bf16 v[56:59], v[108:111], v[68:71], v[56:59]
    s_waitcnt lgkmcnt(4)
    v_mfma_f32_16x16x32_bf16 v[48:51], v[112:115], v[72:75], v[48:51]
    s_waitcnt lgkmcnt(2)
    v_mfma_f32_16x16x32_bf16 v[52:55], v[116:119], v[72:75], v[52:55]
    s_waitcnt lgkmcnt(0)
    v_mfma_f32_16x16x32_bf16 v[56:59], v[120:123], v[72:75], v[56:59]
    s_waitcnt vmcnt(8)
    s_barrier
    s_add_u32 m0, s63, 16384
    s_movk_i32 s52, 1024
    buffer_load_dwordx4 v35, s[24:27], s52 offen lds
    s_add_u32 m0, s63, 24576
    s_movk_i32 s52, 1152
    buffer_load_dwordx4 v35, s[24:27], s52 offen lds
    s_add_u32 m0, s62, 24576
    s_mov_b32 s52, 245760
    buffer_load_dwordx4 v32, s[20:23], s52 offen offset:0 nt lds
    buffer_load_dwordx4 v33, s[20:23], s52 offen offset:1024 nt lds
    buffer_load_dwordx4 v34, s[20:23], s52 offen offset:2048 nt lds
    ds_read_b128 v[60:63], v36 offset:32768
    ds_read_b64_tr_b16 v[76:77], v41 offset:0
    ds_read_b64_tr_b16 v[78:79], v41 offset:768
    ds_read_b64_tr_b16 v[80:81], v42 offset:0
    ds_read_b64_tr_b16 v[82:83], v42 offset:768
    ds_read_b64_tr_b16 v[84:85], v43 offset:0
    ds_read_b64_tr_b16 v[86:87], v43 offset:768
    ds_read_b128 v[64:67], v37 offset:32768
    ds_read_b64_tr_b16 v[88:89], v41 offset:6144
    ds_read_b64_tr_b16 v[90:91], v41 offset:6912
    ds_read_b64_tr_b16 v[92:93], v42 offset:6144
    ds_read_b64_tr_b16 v[94:95], v42 offset:6912
    ds_read_b64_tr_b16 v[96:97], v43 offset:6144
    ds_read_b64_tr_b16 v[98:99], v43 offset:6912
    s_waitcnt lgkmcnt(11)
    v_mfma_f32_16x16x32_bf16 v[48:51], v[76:79], v[60:63], v[48:51]
    s_waitcnt lgkmcnt(9)
    v_mfma_f32_16x16x32_bf16 v[52:55], v[80:83], v[60:63], v[52:55]
    s_waitcnt lgkmcnt(7)
    v_mfma_f32_16x16x32_bf16 v[56:59], v[84:87], v[60:63], v[56:59]
    ds_read_b128 v[68:71], v36 offset:40960
    ds_read_b64_tr_b16 v[100:101], v41 offset:12288
    ds_read_b64_tr_b16 v[102:103], v41 offset:13056
    ds_read_b64_tr_b16 v[104:105], v42 offset:12288
    ds_read_b64_tr_b16 v[106:107], v42 offset:13056
    ds_read_b64_tr_b16 v[108:109], v43 offset:12288
    ds_read_b64_tr_b16 v[110:111], v43 offset:13056
    s_waitcnt lgkmcnt(11)
    v_mfma_f32_16x16x32_bf16 v[48:51], v[88:91], v[64:67], v[48:51]
    s_waitcnt lgkmcnt(9)
    v_mfma_f32_16x16x32_bf16 v[52:55], v[92:95], v[64:67], v[52:55]
    s_waitcnt lgkmcnt(7)
    v_mfma_f32_16x16x32_bf16 v[56:59], v[96:99], v[64:67], v[56:59]
    ds_read_b128 v[72:75], v37 offset:40960
    ds_read_b64_tr_b16 v[112:113], v41 offset:18432
    ds_read_b64_tr_b16 v[114:115], v41 offset:19200
    ds_read_b64_tr_b16 v[116:117], v42 offset:18432
    ds_read_b64_tr_b16 v[118:119], v42 offset:19200
    ds_read_b64_tr_b16 v[120:121], v43 offset:18432
    ds_read_b64_tr_b16 v[122:123], v43 offset:19200
    s_waitcnt lgkmcnt(11)
    v_mfma_f32_16x16x32_bf16 v[48:51], v[100:103], v[68:71], v[48:51]
    s_waitcnt lgkmcnt(9)
    v_mfma_f32_16x16x32_bf16 v[52:55], v[104:107], v[68:71], v[52:55]
    s_waitcnt lgkmcnt(7)
    v_mfma_f32_16x16x32_bf16 v[56:59], v[108:111], v[68:71], v[56:59]
    s_waitcnt lgkmcnt(4)
    v_mfma_f32_16x16x32_bf16 v[48:51], v[112:115], v[72:75], v[48:51]
    s_waitcnt lgkmcnt(2)
    v_mfma_f32_16x16x32_bf16 v[52:55], v[116:119], v[72:75], v[52:55]
    s_waitcnt lgkmcnt(0)
    v_mfma_f32_16x16x32_bf16 v[56:59], v[120:123], v[72:75], v[56:59]
    s_waitcnt vmcnt(8)
    s_barrier
    s_add_u32 m0, s63, 32768
    s_movk_i32 s52, 1280
    buffer_load_dwordx4 v35, s[24:27], s52 offen lds
    s_add_u32 m0, s63, 40960
    s_movk_i32 s52, 1408
    buffer_load_dwordx4 v35, s[24:27], s52 offen lds
    s_add_u32 m0, s62, 49152
    s_mov_b32 s52, 294912
    buffer_load_dwordx4 v32, s[20:23], s52 offen offset:0 nt lds
    buffer_load_dwordx4 v33, s[20:23], s52 offen offset:1024 nt lds
    buffer_load_dwordx4 v34, s[20:23], s52 offen offset:2048 nt lds
    ds_read_b128 v[60:63], v36 offset:0
    ds_read_b64_tr_b16 v[76:77], v41 offset:24576
    ds_read_b64_tr_b16 v[78:79], v41 offset:25344
    ds_read_b64_tr_b16 v[80:81], v42 offset:24576
    ds_read_b64_tr_b16 v[82:83], v42 offset:25344
    ds_read_b64_tr_b16 v[84:85], v43 offset:24576
    ds_read_b64_tr_b16 v[86:87], v43 offset:25344
    ds_read_b128 v[64:67], v37 offset:0
    ds_read_b64_tr_b16 v[88:89], v41 offset:30720
    ds_read_b64_tr_b16 v[90:91], v41 offset:31488
    ds_read_b64_tr_b16 v[92:93], v42 offset:30720
    ds_read_b64_tr_b16 v[94:95], v42 offset:31488
    ds_read_b64_tr_b16 v[96:97], v43 offset:30720
    ds_read_b64_tr_b16 v[98:99], v43 offset:31488
    s_waitcnt lgkmcnt(11)
    v_mfma_f32_16x16x32_bf16 v[48:51], v[76:79], v[60:63], v[48:51]
    s_waitcnt lgkmcnt(9)
    v_mfma_f32_16x16x32_bf16 v[52:55], v[80:83], v[60:63], v[52:55]
    s_waitcnt lgkmcnt(7)
    v_mfma_f32_16x16x32_bf16 v[56:59], v[84:87], v[60:63], v[56:59]
    ds_read_b128 v[68:71], v36 offset:8192
    ds_read_b64_tr_b16 v[100:101], v41 offset:36864
    ds_read_b64_tr_b16 v[102:103], v41 offset:37632
    ds_read_b64_tr_b16 v[104:105], v42 offset:36864
    ds_read_b64_tr_b16 v[106:107], v42 offset:37632
    ds_read_b64_tr_b16 v[108:109], v43 offset:36864
    ds_read_b64_tr_b16 v[110:111], v43 offset:37632
    s_waitcnt lgkmcnt(11)
    v_mfma_f32_16x16x32_bf16 v[48:51], v[88:91], v[64:67], v[48:51]
    s_waitcnt lgkmcnt(9)
    v_mfma_f32_16x16x32_bf16 v[52:55], v[92:95], v[64:67], v[52:55]
    s_waitcnt lgkmcnt(7)
    v_mfma_f32_16x16x32_bf16 v[56:59], v[96:99], v[64:67], v[56:59]
    ds_read_b128 v[72:75], v37 offset:8192
    ds_read_b64_tr_b16 v[112:113], v41 offset:43008
    ds_read_b64_tr_b16 v[114:115], v41 offset:43776
    ds_read_b64_tr_b16 v[116:117], v42 offset:43008
    ds_read_b64_tr_b16 v[118:119], v42 offset:43776
    ds_read_b64_tr_b16 v[120:121], v43 offset:43008
    ds_read_b64_tr_b16 v[122:123], v43 offset:43776
    s_waitcnt lgkmcnt(11)
    v_mfma_f32_16x16x32_bf16 v[48:51], v[100:103], v[68:71], v[48:51]
    s_waitcnt lgkmcnt(9)
    v_mfma_f32_16x16x32_bf16 v[52:55], v[104:107], v[68:71], v[52:55]
    s_waitcnt lgkmcnt(7)
    v_mfma_f32_16x16x32_bf16 v[56:59], v[108:111], v[68:71], v[56:59]
    s_waitcnt lgkmcnt(4)
    v_mfma_f32_16x16x32_bf16 v[48:51], v[112:115], v[72:75], v[48:51]
    s_waitcnt lgkmcnt(2)
    v_mfma_f32_16x16x32_bf16 v[52:55], v[116:119], v[72:75], v[52:55]
    s_waitcnt lgkmcnt(0)
    v_mfma_f32_16x16x32_bf16 v[56:59], v[120:123], v[72:75], v[56:59]
    s_waitcnt vmcnt(8)
    s_barrier
    s_add_u32 m0, s63, 0
    s_movk_i32 s52, 1536
    buffer_load_dwordx4 v35, s[24:27], s52 offen lds
    s_add_u32 m0, s63, 8192
    s_movk_i32 s52, 1664
    buffer_load_dwordx4 v35, s[24:27], s52 offen lds
    s_add_u32 m0, s62, 73728
    s_mov_b32 s52, 344064
    buffer_load_dwordx4 v32, s[20:23], s52 offen offset:0 nt lds
    buffer_load_dwordx4 v33, s[20:23], s52 offen offset:1024 nt lds
    buffer_load_dwordx4 v34, s[20:23], s52 offen offset:2048 nt lds
    ds_read_b128 v[60:63], v36 offset:16384
    ds_read_b64_tr_b16 v[76:77], v38 offset:0
    ds_read_b64_tr_b16 v[78:79], v38 offset:768
    ds_read_b64_tr_b16 v[80:81], v39 offset:0
    ds_read_b64_tr_b16 v[82:83], v39 offset:768
    ds_read_b64_tr_b16 v[84:85], v40 offset:0
    ds_read_b64_tr_b16 v[86:87], v40 offset:768
    ds_read_b128 v[64:67], v37 offset:16384
    ds_read_b64_tr_b16 v[88:89], v38 offset:6144
    ds_read_b64_tr_b16 v[90:91], v38 offset:6912
    ds_read_b64_tr_b16 v[92:93], v39 offset:6144
    ds_read_b64_tr_b16 v[94:95], v39 offset:6912
    ds_read_b64_tr_b16 v[96:97], v40 offset:6144
    ds_read_b64_tr_b16 v[98:99], v40 offset:6912
    s_waitcnt lgkmcnt(11)
    v_mfma_f32_16x16x32_bf16 v[48:51], v[76:79], v[60:63], v[48:51]
    s_waitcnt lgkmcnt(9)
    v_mfma_f32_16x16x32_bf16 v[52:55], v[80:83], v[60:63], v[52:55]
    s_waitcnt lgkmcnt(7)
    v_mfma_f32_16x16x32_bf16 v[56:59], v[84:87], v[60:63], v[56:59]
    ds_read_b128 v[68:71], v36 offset:24576
    ds_read_b64_tr_b16 v[100:101], v38 offset:12288
    ds_read_b64_tr_b16 v[102:103], v38 offset:13056
    ds_read_b64_tr_b16 v[104:105], v39 offset:12288
    ds_read_b64_tr_b16 v[106:107], v39 offset:13056
    ds_read_b64_tr_b16 v[108:109], v40 offset:12288
    ds_read_b64_tr_b16 v[110:111], v40 offset:13056
    s_waitcnt lgkmcnt(11)
    v_mfma_f32_16x16x32_bf16 v[48:51], v[88:91], v[64:67], v[48:51]
    s_waitcnt lgkmcnt(9)
    v_mfma_f32_16x16x32_bf16 v[52:55], v[92:95], v[64:67], v[52:55]
    s_waitcnt lgkmcnt(7)
    v_mfma_f32_16x16x32_bf16 v[56:59], v[96:99], v[64:67], v[56:59]
    ds_read_b128 v[72:75], v37 offset:24576
    ds_read_b64_tr_b16 v[112:113], v38 offset:18432
    ds_read_b64_tr_b16 v[114:115], v38 offset:19200
    ds_read_b64_tr_b16 v[116:117], v39 offset:18432
    ds_read_b64_tr_b16 v[118:119], v39 offset:19200
    ds_read_b64_tr_b16 v[120:121], v40 offset:18432
    ds_read_b64_tr_b16 v[122:123], v40 offset:19200
    s_waitcnt lgkmcnt(11)
    v_mfma_f32_16x16x32_bf16 v[48:51], v[100:103], v[68:71], v[48:51]
    s_waitcnt lgkmcnt(9)
    v_mfma_f32_16x16x32_bf16 v[52:55], v[104:107], v[68:71], v[52:55]
    s_waitcnt lgkmcnt(7)
    v_mfma_f32_16x16x32_bf16 v[56:59], v[108:111], v[68:71], v[56:59]
    s_waitcnt lgkmcnt(4)
    v_mfma_f32_16x16x32_bf16 v[48:51], v[112:115], v[72:75], v[48:51]
    s_waitcnt lgkmcnt(2)
    v_mfma_f32_16x16x32_bf16 v[52:55], v[116:119], v[72:75], v[52:55]
    s_waitcnt lgkmcnt(0)
    v_mfma_f32_16x16x32_bf16 v[56:59], v[120:123], v[72:75], v[56:59]
    s_waitcnt vmcnt(8)
    s_barrier
    s_add_u32 m0, s63, 16384
    s_movk_i32 s52, 1792
    buffer_load_dwordx4 v35, s[24:27], s52 offen lds
    s_add_u32 m0, s63, 24576
    s_movk_i32 s52, 1920
    buffer_load_dwordx4 v35, s[24:27], s52 offen lds
    ds_read_b128 v[60:63], v36 offset:32768
    ds_read_b64_tr_b16 v[76:77], v38 offset:24576
    ds_read_b64_tr_b16 v[78:79], v38 offset:25344
    ds_read_b64_tr_b16 v[80:81], v39 offset:24576
    ds_read_b64_tr_b16 v[82:83], v39 offset:25344
    ds_read_b64_tr_b16 v[84:85], v40 offset:24576
    ds_read_b64_tr_b16 v[86:87], v40 offset:25344
    ds_read_b128 v[64:67], v37 offset:32768
    ds_read_b64_tr_b16 v[88:89], v38 offset:30720
    ds_read_b64_tr_b16 v[90:91], v38 offset:31488
    ds_read_b64_tr_b16 v[92:93], v39 offset:30720
    ds_read_b64_tr_b16 v[94:95], v39 offset:31488
    ds_read_b64_tr_b16 v[96:97], v40 offset:30720
    ds_read_b64_tr_b16 v[98:99], v40 offset:31488
    s_waitcnt lgkmcnt(11)
    v_mfma_f32_16x16x32_bf16 v[48:51], v[76:79], v[60:63], v[48:51]
    s_waitcnt lgkmcnt(9)
    v_mfma_f32_16x16x32_bf16 v[52:55], v[80:83], v[60:63], v[52:55]
    s_waitcnt lgkmcnt(7)
    v_mfma_f32_16x16x32_bf16 v[56:59], v[84:87], v[60:63], v[56:59]
    ds_read_b128 v[68:71], v36 offset:40960
    ds_read_b64_tr_b16 v[100:101], v38 offset:36864
    ds_read_b64_tr_b16 v[102:103], v38 offset:37632
    ds_read_b64_tr_b16 v[104:105], v39 offset:36864
    ds_read_b64_tr_b16 v[106:107], v39 offset:37632
    ds_read_b64_tr_b16 v[108:109], v40 offset:36864
    ds_read_b64_tr_b16 v[110:111], v40 offset:37632
    s_waitcnt lgkmcnt(11)
    v_mfma_f32_16x16x32_bf16 v[48:51], v[88:91], v[64:67], v[48:51]
    s_waitcnt lgkmcnt(9)
    v_mfma_f32_16x16x32_bf16 v[52:55], v[92:95], v[64:67], v[52:55]
    s_waitcnt lgkmcnt(7)
    v_mfma_f32_16x16x32_bf16 v[56:59], v[96:99], v[64:67], v[56:59]
    ds_read_b128 v[72:75], v37 offset:40960
    ds_read_b64_tr_b16 v[112:113], v38 offset:43008
    ds_read_b64_tr_b16 v[114:115], v38 offset:43776
    ds_read_b64_tr_b16 v[116:117], v39 offset:43008
    ds_read_b64_tr_b16 v[118:119], v39 offset:43776
    ds_read_b64_tr_b16 v[120:121], v40 offset:43008
    ds_read_b64_tr_b16 v[122:123], v40 offset:43776
    s_waitcnt lgkmcnt(11)
    v_mfma_f32_16x16x32_bf16 v[48:51], v[100:103], v[68:71], v[48:51]
    s_waitcnt lgkmcnt(9)
    v_mfma_f32_16x16x32_bf16 v[52:55], v[104:107], v[68:71], v[52:55]
    s_waitcnt lgkmcnt(7)
    v_mfma_f32_16x16x32_bf16 v[56:59], v[108:111], v[68:71], v[56:59]
    s_waitcnt lgkmcnt(4)
    v_mfma_f32_16x16x32_bf16 v[48:51], v[112:115], v[72:75], v[48:51]
    s_waitcnt lgkmcnt(2)
    v_mfma_f32_16x16x32_bf16 v[52:55], v[116:119], v[72:75], v[52:55]
    s_waitcnt lgkmcnt(0)
    v_mfma_f32_16x16x32_bf16 v[56:59], v[120:123], v[72:75], v[56:59]
    s_waitcnt vmcnt(5)
    s_barrier
    ds_read_b128 v[60:63], v36 offset:0
    ds_read_b64_tr_b16 v[76:77], v41 offset:0
    ds_read_b64_tr_b16 v[78:79], v41 offset:768
    ds_read_b64_tr_b16 v[80:81], v42 offset:0
    ds_read_b64_tr_b16 v[82:83], v42 offset:768
    ds_read_b64_tr_b16 v[84:85], v43 offset:0
    ds_read_b64_tr_b16 v[86:87], v43 offset:768
    ds_read_b128 v[64:67], v37 offset:0
    ds_read_b64_tr_b16 v[88:89], v41 offset:6144
    ds_read_b64_tr_b16 v[90:91], v41 offset:6912
    ds_read_b64_tr_b16 v[92:93], v42 offset:6144
    ds_read_b64_tr_b16 v[94:95], v42 offset:6912
    ds_read_b64_tr_b16 v[96:97], v43 offset:6144
    ds_read_b64_tr_b16 v[98:99], v43 offset:6912
    s_waitcnt lgkmcnt(11)
    v_mfma_f32_16x16x32_bf16 v[48:51], v[76:79], v[60:63], v[48:51]
    s_waitcnt lgkmcnt(9)
    v_mfma_f32_16x16x32_bf16 v[52:55], v[80:83], v[60:63], v[52:55]
    s_waitcnt lgkmcnt(7)
    v_mfma_f32_16x16x32_bf16 v[56:59], v[84:87], v[60:63], v[56:59]
    ds_read_b128 v[68:71], v36 offset:8192
    ds_read_b64_tr_b16 v[100:101], v41 offset:12288
    ds_read_b64_tr_b16 v[102:103], v41 offset:13056
    ds_read_b64_tr_b16 v[104:105], v42 offset:12288
    ds_read_b64_tr_b16 v[106:107], v42 offset:13056
    ds_read_b64_tr_b16 v[108:109], v43 offset:12288
    ds_read_b64_tr_b16 v[110:111], v43 offset:13056
    s_waitcnt lgkmcnt(11)
    v_mfma_f32_16x16x32_bf16 v[48:51], v[88:91], v[64:67], v[48:51]
    s_waitcnt lgkmcnt(9)
    v_mfma_f32_16x16x32_bf16 v[52:55], v[92:95], v[64:67], v[52:55]
    s_waitcnt lgkmcnt(7)
    v_mfma_f32_16x16x32_bf16 v[56:59], v[96:99], v[64:67], v[56:59]
    ds_read_b128 v[72:75], v37 offset:8192
    ds_read_b64_tr_b16 v[112:113], v41 offset:18432
    ds_read_b64_tr_b16 v[114:115], v41 offset:19200
    ds_read_b64_tr_b16 v[116:117], v42 offset:18432
    ds_read_b64_tr_b16 v[118:119], v42 offset:19200
    ds_read_b64_tr_b16 v[120:121], v43 offset:18432
    ds_read_b64_tr_b16 v[122:123], v43 offset:19200
    s_waitcnt lgkmcnt(11)
    v_mfma_f32_16x16x32_bf16 v[48:51], v[100:103], v[68:71], v[48:51]
    s_waitcnt lgkmcnt(9)
    v_mfma_f32_16x16x32_bf16 v[52:55], v[104:107], v[68:71], v[52:55]
    s_waitcnt lgkmcnt(7)
    v_mfma_f32_16x16x32_bf16 v[56:59], v[108:111], v[68:71], v[56:59]
    s_waitcnt lgkmcnt(4)
    v_mfma_f32_16x16x32_bf16 v[48:51], v[112:115], v[72:75], v[48:51]
    s_waitcnt lgkmcnt(2)
    v_mfma_f32_16x16x32_bf16 v[52:55], v[116:119], v[72:75], v[52:55]
    s_waitcnt lgkmcnt(0)
    v_mfma_f32_16x16x32_bf16 v[56:59], v[120:123], v[72:75], v[56:59]
    s_waitcnt vmcnt(0)
    s_barrier
    ds_read_b128 v[60:63], v36 offset:16384
    ds_read_b64_tr_b16 v[76:77], v41 offset:24576
    ds_read_b64_tr_b16 v[78:79], v41 offset:25344
    ds_read_b64_tr_b16 v[80:81], v42 offset:24576
    ds_read_b64_tr_b16 v[82:83], v42 offset:25344
    ds_read_b64_tr_b16 v[84:85], v43 offset:24576
    ds_read_b64_tr_b16 v[86:87], v43 offset:25344
    ds_read_b128 v[64:67], v37 offset:16384
    ds_read_b64_tr_b16 v[88:89], v41 offset:30720
    ds_read_b64_tr_b16 v[90:91], v41 offset:31488
    ds_read_b64_tr_b16 v[92:93], v42 offset:30720
    ds_read_b64_tr_b16 v[94:95], v42 offset:31488
    ds_read_b64_tr_b16 v[96:97], v43 offset:30720
    ds_read_b64_tr_b16 v[98:99], v43 offset:31488
    s_waitcnt lgkmcnt(11)
    v_mfma_f32_16x16x32_bf16 v[48:51], v[76:79], v[60:63], v[48:51]
    s_waitcnt lgkmcnt(9)
    v_mfma_f32_16x16x32_bf16 v[52:55], v[80:83], v[60:63], v[52:55]
    s_waitcnt lgkmcnt(7)
    v_mfma_f32_16x16x32_bf16 v[56:59], v[84:87], v[60:63], v[56:59]
    ds_read_b128 v[68:71], v36 offset:24576
    ds_read_b64_tr_b16 v[100:101], v41 offset:36864
    ds_read_b64_tr_b16 v[102:103], v41 offset:37632
    ds_read_b64_tr_b16 v[104:105], v42 offset:36864
    ds_read_b64_tr_b16 v[106:107], v42 offset:37632
    ds_read_b64_tr_b16 v[108:109], v43 offset:36864
    ds_read_b64_tr_b16 v[110:111], v43 offset:37632
    s_waitcnt lgkmcnt(11)
    v_mfma_f32_16x16x32_bf16 v[48:51], v[88:91], v[64:67], v[48:51]
    s_waitcnt lgkmcnt(9)
    v_mfma_f32_16x16x32_bf16 v[52:55], v[92:95], v[64:67], v[52:55]
    s_waitcnt lgkmcnt(7)
    v_mfma_f32_16x16x32_bf16 v[56:59], v[96:99], v[64:67], v[56:59]
    ds_read_b128 v[72:75], v37 offset:24576
    ds_read_b64_tr_b16 v[112:113], v41 offset:43008
    ds_read_b64_tr_b16 v[114:115], v41 offset:43776
    ds_read_b64_tr_b16 v[116:117], v42 offset:43008
    ds_read_b64_tr_b16 v[118:119], v42 offset:43776
    ds_read_b64_tr_b16 v[120:121], v43 offset:43008
    ds_read_b64_tr_b16 v[122:123], v43 offset:43776
    s_waitcnt lgkmcnt(11)
    v_mfma_f32_16x16x32_bf16 v[48:51], v[100:103], v[68:71], v[48:51]
    s_waitcnt lgkmcnt(9)
    v_mfma_f32_16x16x32_bf16 v[52:55], v[104:107], v[68:71], v[52:55]
    s_waitcnt lgkmcnt(7)
    v_mfma_f32_16x16x32_bf16 v[56:59], v[108:111], v[68:71], v[56:59]
    s_waitcnt lgkmcnt(4)
    v_mfma_f32_16x16x32_bf16 v[48:51], v[112:115], v[72:75], v[48:51]
    s_waitcnt lgkmcnt(2)
    v_mfma_f32_16x16x32_bf16 v[52:55], v[116:119], v[72:75], v[52:55]
    s_waitcnt lgkmcnt(0)
    v_mfma_f32_16x16x32_bf16 v[56:59], v[120:123], v[72:75], v[56:59]
    s_nop 6
    v_cvt_pk_bf16_f32 v124, v48, v49
    v_cvt_pk_bf16_f32 v125, v50, v51
    v_cvt_pk_bf16_f32 v126, v52, v53
    v_cvt_pk_bf16_f32 v127, v54, v55
    s_nop 1
    v_permlane16_swap_b32 v124, v126
    v_permlane16_swap_b32 v125, v127
    v_cvt_pk_bf16_f32 v128, v56, v57
    v_cvt_pk_bf16_f32 v129, v58, v59
    buffer_store_dwordx4 v[124:127], v44, s[36:39], s4 offen sc1
    s_nop 0
    v_permlane16_swap_b32 v128, v130
    v_permlane16_swap_b32 v129, v131
    s_mov_b64 exec, s[94:95]
    s_nop 0
    buffer_store_dwordx4 v[128:131], v44, s[36:39], s5 offen sc1
    s_branch L_P1_DONE
L_P1_V:
    s_waitcnt vmcnt(13)
    s_barrier
    ds_read_b128 v[60:63], v36 offset:0
    ds_read_b64_tr_b16 v[76:77], v38 offset:0
    ds_read_b64_tr_b16 v[78:79], v38 offset:768
    ds_read_b64_tr_b16 v[80:81], v39 offset:0
    ds_read_b64_tr_b16 v[82:83], v39 offset:768
    ds_read_b64_tr_b16 v[84:85], v40 offset:0
    ds_read_b64_tr_b16 v[86:87], v40 offset:768
    ds_read_b128 v[64:67], v37 offset:0
    ds_read_b64_tr_b16 v[88:89], v38 offset:6144
    ds_read_b64_tr_b16 v[90:91], v38 offset:6912
    ds_read_b64_tr_b16 v[92:93], v39 offset:6144
    ds_read_b64_tr_b16 v[94:95], v39 offset:6912
    ds_read_b64_tr_b16 v[96:97], v40 offset:6144
    ds_read_b64_tr_b16 v[98:99], v40 offset:6912
    s_waitcnt lgkmcnt(11)
    v_mfma_f32_16x16x32_bf16 v[48:51], v[60:63], v[76:79], 0
    s_waitcnt lgkmcnt(9)
    v_mfma_f32_16x16x32_bf16 v[52:55], v[60:63], v[80:83], 0
    s_waitcnt lgkmcnt(7)
    v_mfma_f32_16x16x32_bf16 v[56:59], v[60:63], v[84:87], 0
    ds_read_b128 v[68:71], v36 offset:8192
    ds_read_b64_tr_b16 v[100:101], v38 offset:12288
    ds_read_b64_tr_b16 v[102:103], v38 offset:13056
    ds_read_b64_tr_b16 v[104:105], v39 offset:12288
    ds_read_b64_tr_b16 v[106:107], v39 offset:13056
    ds_read_b64_tr_b16 v[108:109], v40 offset:12288
    ds_read_b64_tr_b16 v[110:111], v40 offset:13056
    s_waitcnt lgkmcnt(11)
    v_mfma_f32_16x16x32_bf16 v[48:51], v[64:67], v[88:91], v[48:51]
    s_waitcnt lgkmcnt(9)
    v_mfma_f32_16x16x32_bf16 v[52:55], v[64:67], v[92:95], v[52:55]
    s_waitcnt lgkmcnt(7)
    v_mfma_f32_16x16x32_bf16 v[56:59], v[64:67], v[96:99], v[56:59]
    ds_read_b128 v[72:75], v37 offset:8192
    ds_read_b64_tr_b16 v[112:113], v38 offset:18432
    ds_read_b64_tr_b16 v[114:115], v38 offset:19200
    ds_read_b64_tr_b16 v[116:117], v39 offset:18432
    ds_read_b64_tr_b16 v[118:119], v39 offset:19200
    ds_read_b64_tr_b16 v[120:121], v40 offset:18432
    ds_read_b64_tr_b16 v[122:123], v40 offset:19200
    s_waitcnt lgkmcnt(11)
    v_mfma_f32_16x16x32_bf16 v[48:51], v[68:71], v[100:103], v[48:51]
    s_waitcnt lgkmcnt(9)
    v_mfma_f32_16x16x32_bf16 v[52:55], v[68:71], v[104:107], v[52:55]
    s_waitcnt lgkmcnt(7)
    v_mfma_f32_16x16x32_bf16 v[56:59], v[68:71], v[108:111], v[56:59]
    s_waitcnt lgkmcnt(4)
    v_mfma_f32_16x16x32_bf16 v[48:51], v[72:75], v[112:115], v[48:51]
    s_waitcnt lgkmcnt(2)
    v_mfma_f32_16x16x32_bf16 v[52:55], v[72:75], v[116:119], v[52:55]
    s_waitcnt lgkmcnt(0)
    v_mfma_f32_16x16x32_bf16 v[56:59], v[72:75], v[120:123], v[56:59]
    s_waitcnt vmcnt(8)
    s_barrier
    s_add_u32 m0, s63, 0
    s_movk_i32 s52, 768
    buffer_load_dwordx4 v35, s[24:27], s52 offen lds
    s_add_u32 m0, s63, 8192
    s_movk_i32 s52, 896
    buffer_load_dwordx4 v35, s[24:27], s52 offen lds
    s_add_u32 m0, s62, 0
    s_mov_b32 s52, 196608
    buffer_load_dwordx4 v32, s[20:23], s52 offen offset:0 nt lds
    buffer_load_dwordx4 v33, s[20:23], s52 offen offset:1024 nt lds
    buffer_load_dwordx4 v34, s[20:23], s52 offen offset:2048 nt lds
    ds_read_b128 v[60:63], v36 offset:16384
    ds_read_b64_tr_b16 v[76:77], v38 offset:24576
    ds_read_b64_tr_b16 v[78:79], v38 offset:25344
    ds_read_b64_tr_b16 v[80:81], v39 offset:24576
    ds_read_b64_tr_b16 v[82:83], v39 offset:25344
    ds_read_b64_tr_b16 v[84:85], v40 offset:24576
    ds_read_b64_tr_b16 v[86:87], v40 offset:25344
    ds_read_b128 v[64:67], v37 offset:16384
    ds_read_b64_tr_b16 v[88:89], v38 offset:30720
    ds_read_b64_tr_b16 v[90:91], v38 offset:31488
    ds_read_b64_tr_b16 v[92:93], v39 offset:30720
    ds_read_b64_tr_b16 v[94:95], v39 offset:31488
    ds_read_b64_tr_b16 v[96:97], v40 offset:30720
    ds_read_b64_tr_b16 v[98:99], v40 offset:31488
    s_waitcnt lgkmcnt(11)
    v_mfma_f32_16x16x32_bf16 v[48:51], v[60:63], v[76:79], v[48:51]
    s_waitcnt lgkmcnt(9)
    v_mfma_f32_16x16x32_bf16 v[52:55], v[60:63], v[80:83], v[52:55]
    s_waitcnt lgkmcnt(7)
    v_mfma_f32_16x16x32_bf16 v[56:59], v[60:63], v[84:87], v[56:59]
    ds_read_b128 v[68:71], v36 offset:24576
    ds_read_b64_tr_b16 v[100:101], v38 offset:36864
    ds_read_b64_tr_b16 v[102:103], v38 offset:37632
    ds_read_b64_tr_b16 v[104:105], v39 offset:36864
    ds_read_b64_tr_b16 v[106:107], v39 offset:37632
    ds_read_b64_tr_b16 v[108:109], v40 offset:36864
    ds_read_b64_tr_b16 v[110:111], v40 offset:37632
    s_waitcnt lgkmcnt(11)
    v_mfma_f32_16x16x32_bf16 v[48:51], v[64:67], v[88:91], v[48:51]
    s_waitcnt lgkmcnt(9)
    v_mfma_f32_16x16x32_bf16 v[52:55], v[64:67], v[92:95], v[52:55]
    s_waitcnt lgkmcnt(7)
    v_mfma_f32_16x16x32_bf16 v[56:59], v[64:67], v[96:99], v[56:59]
    ds_read_b128 v[72:75], v37 offset:24576
    ds_read_b64_tr_b16 v[112:113], v38 offset:43008
    ds_read_b64_tr_b16 v[114:115], v38 offset:43776
    ds_read_b64_tr_b16 v[116:117], v39 offset:43008
    ds_read_b64_tr_b16 v[118:119], v39 offset:43776
    ds_read_b64_tr_b16 v[120:121], v40 offset:43008
    ds_read_b64_tr_b16 v[122:123], v40 offset:43776
    s_waitcnt lgkmcnt(11)
    v_mfma_f32_16x16x32_bf16 v[48:51], v[68:71], v[100:103], v[48:51]
    s_waitcnt lgkmcnt(9)
    v_mfma_f32_16x16x32_bf16 v[52:55], v[68:71], v[104:107], v[52:55]
    s_waitcnt lgkmcnt(7)
    v_mfma_f32_16x16x32_bf16 v[56:59], v[68:71], v[108:111], v[56:59]
    s_waitcnt lgkmcnt(4)
    v_mfma_f32_16x16x32_bf16 v[48:51], v[72:75], v[112:115], v[48:51]
    s_waitcnt lgkmcnt(2)
    v_mfma_f32_16x16x32_bf16 v[52:55], v[72:75], v[116:119], v[52:55]
    s_waitcnt lgkmcnt(0)
    v_mfma_f32_16x16x32_bf16 v[56:59], v[72:75], v[120:123], v[56:59]
    s_waitcnt vmcnt(8)
    s_barrier
    s_add_u32 m0, s63, 16384
    s_movk_i32 s52, 1024
    buffer_load_dwordx4 v35, s[24:27], s52 offen lds
    s_add_u32 m0, s63, 24576
    s_movk_i32 s52, 1152
    buffer_load_dwordx4 v35, s[24:27], s52 offen lds
    s_add_u32 m0, s62, 24576
    s_mov_b32 s52, 245760
    buffer_load_dwordx4 v32, s[20:23], s52 offen offset:0 nt lds
    buffer_load_dwordx4 v33, s[20:23], s52 offen offset:1024 nt lds
    buffer_load_dwordx4 v34, s[20:23], s52 offen offset:2048 nt lds
    ds_read_b128 v[60:63], v36 offset:32768
    ds_read_b64_tr_b16 v[76:77], v41 offset:0
    ds_read_b64_tr_b16 v[78:79], v41 offset:768
    ds_read_b64_tr_b16 v[80:81], v42 offset:0
    ds_read_b64_tr_b16 v[82:83], v42 offset:768
    ds_read_b64_tr_b16 v[84:85], v43 offset:0
    ds_read_b64_tr_b16 v[86:87], v43 offset:768
    ds_read_b128 v[64:67], v37 offset:32768
    ds_read_b64_tr_b16 v[88:89], v41 offset:6144
    ds_read_b64_tr_b16 v[90:91], v41 offset:6912
    ds_read_b64_tr_b16 v[92:93], v42 offset:6144
    ds_read_b64_tr_b16 v[94:95], v42 offset:6912
    ds_read_b64_tr_b16 v[96:97], v43 offset:6144
    ds_read_b64_tr_b16 v[98:99], v43 offset:6912
    s_waitcnt lgkmcnt(11)
    v_mfma_f32_16x16x32_bf16 v[48:51], v[60:63], v[76:79], v[48:51]
    s_waitcnt lgkmcnt(9)
    v_mfma_f32_16x16x32_bf16 v[52:55], v[60:63], v[80:83], v[52:55]
    s_waitcnt lgkmcnt(7)
    v_mfma_f32_16x16x32_bf16 v[56:59], v[60:63], v[84:87], v[56:59]
    ds_read_b128 v[68:71], v36 offset:40960
    ds_read_b64_tr_b16 v[100:101], v41 offset:12288
    ds_read_b64_tr_b16 v[102:103], v41 offset:13056
    ds_read_b64_tr_b16 v[104:105], v42 offset:12288
    ds_read_b64_tr_b16 v[106:107], v42 offset:13056
    ds_read_b64_tr_b16 v[108:109], v43 offset:12288
    ds_read_b64_tr_b16 v[110:111], v43 offset:13056
    s_waitcnt lgkmcnt(11)
    v_mfma_f32_16x16x32_bf16 v[48:51], v[64:67], v[88:91], v[48:51]
    s_waitcnt lgkmcnt(9)
    v_mfma_f32_16x16x32_bf16 v[52:55], v[64:67], v[92:95], v[52:55]
    s_waitcnt lgkmcnt(7)
    v_mfma_f32_16x16x32_bf16 v[56:59], v[64:67], v[96:99], v[56:59]
    ds_read_b128 v[72:75], v37 offset:40960
    ds_read_b64_tr_b16 v[112:113], v41 offset:18432
    ds_read_b64_tr_b16 v[114:115], v41 offset:19200
    ds_read_b64_tr_b16 v[116:117], v42 offset:18432
    ds_read_b64_tr_b16 v[118:119], v42 offset:19200
    ds_read_b64_tr_b16 v[120:121], v43 offset:18432
    ds_read_b64_tr_b16 v[122:123], v43 offset:19200
    s_waitcnt lgkmcnt(11)
    v_mfma_f32_16x16x32_bf16 v[48:51], v[68:71], v[100:103], v[48:51]
    s_waitcnt lgkmcnt(9)
    v_mfma_f32_16x16x32_bf16 v[52:55], v[68:71], v[104:107], v[52:55]
    s_waitcnt lgkmcnt(7)
    v_mfma_f32_16x16x32_bf16 v[56:59], v[68:71], v[108:111], v[56:59]
    s_waitcnt lgkmcnt(4)
    v_mfma_f32_16x16x32_bf16 v[48:51], v[72:75], v[112:115], v[48:51]
    s_waitcnt lgkmcnt(2)
    v_mfma_f32_16x16x32_bf16 v[52:55], v[72:75], v[116:119], v[52:55]
    s_waitcnt lgkmcnt(0)
    v_mfma_f32_16x16x32_bf16 v[56:59], v[72:75], v[120:123], v[56:59]
    s_waitcnt vmcnt(8)
    s_barrier
    s_add_u32 m0, s63, 32768
    s_movk_i32 s52, 1280
    buffer_load_dwordx4 v35, s[24:27], s52 offen lds
    s_add_u32 m0, s63, 40960
    s_movk_i32 s52, 1408
    buffer_load_dwordx4 v35, s[24:27], s52 offen lds
    s_add_u32 m0, s62, 49152
    s_mov_b32 s52, 294912
    buffer_load_dwordx4 v32, s[20:23], s52 offen offset:0 nt lds
    buffer_load_dwordx4 v33, s[20:23], s52 offen offset:1024 nt lds
    buffer_load_dwordx4 v34, s[20:23], s52 offen offset:2048 nt lds
    ds_read_b128 v[60:63], v36 offset:0
    ds_read_b64_tr_b16 v[76:77], v41 offset:24576
    ds_read_b64_tr_b16 v[78:79], v41 offset:25344
    ds_read_b64_tr_b16 v[80:81], v42 offset:24576
    ds_read_b64_tr_b16 v[82:83], v42 offset:25344
    ds_read_b64_tr_b16 v[84:85], v43 offset:24576
    ds_read_b64_tr_b16 v[86:87], v43 offset:25344
    ds_read_b128 v[64:67], v37 offset:0
    ds_read_b64_tr_b16 v[88:89], v41 offset:30720
    ds_read_b64_tr_b16 v[90:91], v41 offset:31488
    ds_read_b64_tr_b16 v[92:93], v42 offset:30720
    ds_read_b64_tr_b16 v[94:95], v42 offset:31488
    ds_read_b64_tr_b16 v[96:97], v43 offset:30720
    ds_read_b64_tr_b16 v[98:99], v43 offset:31488
    s_waitcnt lgkmcnt(11)
    v_mfma_f32_16x16x32_bf16 v[48:51], v[60:63], v[76:79], v[48:51]
    s_waitcnt lgkmcnt(9)
    v_mfma_f32_16x16x32_bf16 v[52:55], v[60:63], v[80:83], v[52:55]
    s_waitcnt lgkmcnt(7)
    v_mfma_f32_16x16x32_bf16 v[56:59], v[60:63], v[84:87], v[56:59]
    ds_read_b128 v[68:71], v36 offset:8192
    ds_read_b64_tr_b16 v[100:101], v41 offset:36864
    ds_read_b64_tr_b16 v[102:103], v41 offset:37632
    ds_read_b64_tr_b16 v[104:105], v42 offset:36864
    ds_read_b64_tr_b16 v[106:107], v42 offset:37632
    ds_read_b64_tr_b16 v[108:109], v43 offset:36864
    ds_read_b64_tr_b16 v[110:111], v43 offset:37632
    s_waitcnt lgkmcnt(11)
    v_mfma_f32_16x16x32_bf16 v[48:51], v[64:67], v[88:91], v[48:51]
    s_waitcnt lgkmcnt(9)
    v_mfma_f32_16x16x32_bf16 v[52:55], v[64:67], v[92:95], v[52:55]
    s_waitcnt lgkmcnt(7)
    v_mfma_f32_16x16x32_bf16 v[56:59], v[64:67], v[96:99], v[56:59]
    ds_read_b128 v[72:75], v37 offset:8192
    ds_read_b64_tr_b16 v[112:113], v41 offset:43008
    ds_read_b64_tr_b16 v[114:115], v41 offset:43776
    ds_read_b64_tr_b16 v[116:117], v42 offset:43008
    ds_read_b64_tr_b16 v[118:119], v42 offset:43776
    ds_read_b64_tr_b16 v[120:121], v43 offset:43008
    ds_read_b64_tr_b16 v[122:123], v43 offset:43776
    s_waitcnt lgkmcnt(11)
    v_mfma_f32_16x16x32_bf16 v[48:51], v[68:71], v[100:103], v[48:51]
    s_waitcnt lgkmcnt(9)
    v_mfma_f32_16x16x32_bf16 v[52:55], v[68:71], v[104:107], v[52:55]
    s_waitcnt lgkmcnt(7)
    v_mfma_f32_16x16x32_bf16 v[56:59], v[68:71], v[108:111], v[56:59]
    s_waitcnt lgkmcnt(4)
    v_mfma_f32_16x16x32_bf16 v[48:51], v[72:75], v[112:115], v[48:51]
    s_waitcnt lgkmcnt(2)
    v_mfma_f32_16x16x32_bf16 v[52:55], v[72:75], v[116:119], v[52:55]
    s_waitcnt lgkmcnt(0)
    v_mfma_f32_16x16x32_bf16 v[56:59], v[72:75], v[120:123], v[56:59]
    s_waitcnt vmcnt(8)
    s_barrier
    s_add_u32 m0, s63, 0
    s_movk_i32 s52, 1536
    buffer_load_dwordx4 v35, s[24:27], s52 offen lds
    s_add_u32 m0, s63, 8192
    s_movk_i32 s52, 1664
    buffer_load_dwordx4 v35, s[24:27], s52 offen lds
    s_add_u32 m0, s62, 73728
    s_mov_b32 s52, 344064
    buffer_load_dwordx4 v32, s[20:23], s52 offen offset:0 nt lds
    buffer_load_dwordx4 v33, s[20:23], s52 offen offset:1024 nt lds
    buffer_load_dwordx4 v34, s[20:23], s52 offen offset:2048 nt lds
    ds_read_b128 v[60:63], v36 offset:16384
    ds_read_b64_tr_b16 v[76:77], v38 offset:0
    ds_read_b64_tr_b16 v[78:79], v38 offset:768
    ds_read_b64_tr_b16 v[80:81], v39 offset:0
    ds_read_b64_tr_b16 v[82:83], v39 offset:768
    ds_read_b64_tr_b16 v[84:85], v40 offset:0
    ds_read_b64_tr_b16 v[86:87], v40 offset:768
    ds_read_b128 v[64:67], v37 offset:16384
    ds_read_b64_tr_b16 v[88:89], v38 offset:6144
    ds_read_b64_tr_b16 v[90:91], v38 offset:6912
    ds_read_b64_tr_b16 v[92:93], v39 offset:6144
    ds_read_b64_tr_b16 v[94:95], v39 offset:6912
    ds_read_b64_tr_b16 v[96:97], v40 offset:6144
    ds_read_b64_tr_b16 v[98:99], v40 offset:6912
    s_waitcnt lgkmcnt(11)
    v_mfma_f32_16x16x32_bf16 v[48:51], v[60:63], v[76:79], v[48:51]
    s_waitcnt lgkmcnt(9)
    v_mfma_f32_16x16x32_bf16 v[52:55], v[60:63], v[80:83], v[52:55]
    s_waitcnt lgkmcnt(7)
    v_mfma_f32_16x16x32_bf16 v[56:59], v[60:63], v[84:87], v[56:59]
    ds_read_b128 v[68:71], v36 offset:24576
    ds_read_b64_tr_b16 v[100:101], v38 offset:12288
    ds_read_b64_tr_b16 v[102:103], v38 offset:13056
    ds_read_b64_tr_b16 v[104:105], v39 offset:12288
    ds_read_b64_tr_b16 v[106:107], v39 offset:13056
    ds_read_b64_tr_b16 v[108:109], v40 offset:12288
    ds_read_b64_tr_b16 v[110:111], v40 offset:13056
    s_waitcnt lgkmcnt(11)
    v_mfma_f32_16x16x32_bf16 v[48:51], v[64:67], v[88:91], v[48:51]
    s_waitcnt lgkmcnt(9)
    v_mfma_f32_16x16x32_bf16 v[52:55], v[64:67], v[92:95], v[52:55]
    s_waitcnt lgkmcnt(7)
    v_mfma_f32_16x16x32_bf16 v[56:59], v[64:67], v[96:99], v[56:59]
    ds_read_b128 v[72:75], v37 offset:24576
    ds_read_b64_tr_b16 v[112:113], v38 offset:18432
    ds_read_b64_tr_b16 v[114:115], v38 offset:19200
    ds_read_b64_tr_b16 v[116:117], v39 offset:18432
    ds_read_b64_tr_b16 v[118:119], v39 offset:19200
    ds_read_b64_tr_b16 v[120:121], v40 offset:18432
    ds_read_b64_tr_b16 v[122:123], v40 offset:19200
    s_waitcnt lgkmcnt(11)
    v_mfma_f32_16x16x32_bf16 v[48:51], v[68:71], v[100:103], v[48:51]
    s_waitcnt lgkmcnt(9)
    v_mfma_f32_16x16x32_bf16 v[52:55], v[68:71], v[104:107], v[52:55]
    s_waitcnt lgkmcnt(7)
    v_mfma_f32_16x16x32_bf16 v[56:59], v[68:71], v[108:111], v[56:59]
    s_waitcnt lgkmcnt(4)
    v_mfma_f32_16x16x32_bf16 v[48:51], v[72:75], v[112:115], v[48:51]
    s_waitcnt lgkmcnt(2)
    v_mfma_f32_16x16x32_bf16 v[52:55], v[72:75], v[116:119], v[52:55]
    s_waitcnt lgkmcnt(0)
    v_mfma_f32_16x16x32_bf16 v[56:59], v[72:75], v[120:123], v[56:59]
    s_waitcnt vmcnt(8)
    s_barrier
    s_add_u32 m0, s63, 16384
    s_movk_i32 s52, 1792
    buffer_load_dwordx4 v35, s[24:27], s52 offen lds
    s_add_u32 m0, s63, 24576
    s_movk_i32 s52, 1920
    buffer_load_dwordx4 v35, s[24:27], s52 offen lds
    ds_read_b128 v[60:63], v36 offset:32768
    ds_read_b64_tr_b16 v[76:77], v38 offset:24576
    ds_read_b64_tr_b16 v[78:79], v38 offset:25344
    ds_read_b64_tr_b16 v[80:81], v39 offset:24576
    ds_read_b64_tr_b16 v[82:83], v39 offset:25344
    ds_read_b64_tr_b16 v[84:85], v40 offset:24576
    ds_read_b64_tr_b16 v[86:87], v40 offset:25344
    ds_read_b128 v[64:67], v37 offset:32768
    ds_read_b64_tr_b16 v[88:89], v38 offset:30720
    ds_read_b64_tr_b16 v[90:91], v38 offset:31488
    ds_read_b64_tr_b16 v[92:93], v39 offset:30720
    ds_read_b64_tr_b16 v[94:95], v39 offset:31488
    ds_read_b64_tr_b16 v[96:97], v40 offset:30720
    ds_read_b64_tr_b16 v[98:99], v40 offset:31488
    s_waitcnt lgkmcnt(11)
    v_mfma_f32_16x16x32_bf16 v[48:51], v[60:63], v[76:79], v[48:51]
    s_waitcnt lgkmcnt(9)
    v_mfma_f32_16x16x32_bf16 v[52:55], v[60:63], v[80:83], v[52:55]
    s_waitcnt lgkmcnt(7)
    v_mfma_f32_16x16x32_bf16 v[56:59], v[60:63], v[84:87], v[56:59]
    ds_read_b128 v[68:71], v36 offset:40960
    ds_read_b64_tr_b16 v[100:101], v38 offset:36864
    ds_read_b64_tr_b16 v[102:103], v38 offset:37632
    ds_read_b64_tr_b16 v[104:105], v39 offset:36864
    ds_read_b64_tr_b16 v[106:107], v39 offset:37632
    ds_read_b64_tr_b16 v[108:109], v40 offset:36864
    ds_read_b64_tr_b16 v[110:111], v40 offset:37632
    s_waitcnt lgkmcnt(11)
    v_mfma_f32_16x16x32_bf16 v[48:51], v[64:67], v[88:91], v[48:51]
    s_waitcnt lgkmcnt(9)
    v_mfma_f32_16x16x32_bf16 v[52:55], v[64:67], v[92:95], v[52:55]
    s_waitcnt lgkmcnt(7)
    v_mfma_f32_16x16x32_bf16 v[56:59], v[64:67], v[96:99], v[56:59]
    ds_read_b128 v[72:75], v37 offset:40960
    ds_read_b64_tr_b16 v[112:113], v38 offset:43008
    ds_read_b64_tr_b16 v[114:115], v38 offset:43776
    ds_read_b64_tr_b16 v[116:117], v39 offset:43008
    ds_read_b64_tr_b16 v[118:119], v39 offset:43776
    ds_read_b64_tr_b16 v[120:121], v40 offset:43008
    ds_read_b64_tr_b16 v[122:123], v40 offset:43776
    s_waitcnt lgkmcnt(11)
    v_mfma_f32_16x16x32_bf16 v[48:51], v[68:71], v[100:103], v[48:51]
    s_waitcnt lgkmcnt(9)
    v_mfma_f32_16x16x32_bf16 v[52:55], v[68:71], v[104:107], v[52:55]
    s_waitcnt lgkmcnt(7)
    v_mfma_f32_16x16x32_bf16 v[56:59], v[68:71], v[108:111], v[56:59]
    s_waitcnt lgkmcnt(4)
    v_mfma_f32_16x16x32_bf16 v[48:51], v[72:75], v[112:115], v[48:51]
    s_waitcnt lgkmcnt(2)
    v_mfma_f32_16x16x32_bf16 v[52:55], v[72:75], v[116:119], v[52:55]
    s_waitcnt lgkmcnt(0)
    v_mfma_f32_16x16x32_bf16 v[56:59], v[72:75], v[120:123], v[56:59]
    s_waitcnt vmcnt(5)
    s_barrier
    ds_read_b128 v[60:63], v36 offset:0
    ds_read_b64_tr_b16 v[76:77], v41 offset:0
    ds_read_b64_tr_b16 v[78:79], v41 offset:768
    ds_read_b64_tr_b16 v[80:81], v42 offset:0
    ds_read_b64_tr_b16 v[82:83], v42 offset:768
    ds_read_b64_tr_b16 v[84:85], v43 offset:0
    ds_read_b64_tr_b16 v[86:87], v43 offset:768
    ds_read_b128 v[64:67], v37 offset:0
    ds_read_b64_tr_b16 v[88:89], v41 offset:6144
    ds_read_b64_tr_b16 v[90:91], v41 offset:6912
    ds_read_b64_tr_b16 v[92:93], v42 offset:6144
    ds_read_b64_tr_b16 v[94:95], v42 offset:6912
    ds_read_b64_tr_b16 v[96:97], v43 offset:6144
    ds_read_b64_tr_b16 v[98:99], v43 offset:6912
    s_waitcnt lgkmcnt(11)
    v_mfma_f32_16x16x32_bf16 v[48:51], v[60:63], v[76:79], v[48:51]
    s_waitcnt lgkmcnt(9)
    v_mfma_f32_16x16x32_bf16 v[52:55], v[60:63], v[80:83], v[52:55]
    s_waitcnt lgkmcnt(7)
    v_mfma_f32_16x16x32_bf16 v[56:59], v[60:63], v[84:87], v[56:59]
    ds_read_b128 v[68:71], v36 offset:8192
    ds_read_b64_tr_b16 v[100:101], v41 offset:12288
    ds_read_b64_tr_b16 v[102:103], v41 offset:13056
    ds_read_b64_tr_b16 v[104:105], v42 offset:12288
    ds_read_b64_tr_b16 v[106:107], v42 offset:13056
    ds_read_b64_tr_b16 v[108:109], v43 offset:12288
    ds_read_b64_tr_b16 v[110:111], v43 offset:13056
    s_waitcnt lgkmcnt(11)
    v_mfma_f32_16x16x32_bf16 v[48:51], v[64:67], v[88:91], v[48:51]
    s_waitcnt lgkmcnt(9)
    v_mfma_f32_16x16x32_bf16 v[52:55], v[64:67], v[92:95], v[52:55]
    s_waitcnt lgkmcnt(7)
    v_mfma_f32_16x16x32_bf16 v[56:59], v[64:67], v[96:99], v[56:59]
    ds_read_b128 v[72:75], v37 offset:8192
    ds_read_b64_tr_b16 v[112:113], v41 offset:18432
    ds_read_b64_tr_b16 v[114:115], v41 offset:19200
    ds_read_b64_tr_b16 v[116:117], v42 offset:18432
    ds_read_b64_tr_b16 v[118:119], v42 offset:19200
    ds_read_b64_tr_b16 v[120:121], v43 offset:18432
    ds_read_b64_tr_b16 v[122:123], v43 offset:19200
    s_waitcnt lgkmcnt(11)
    v_mfma_f32_16x16x32_bf16 v[48:51], v[68:71], v[100:103], v[48:51]
    s_waitcnt lgkmcnt(9)
    v_mfma_f32_16x16x32_bf16 v[52:55], v[68:71], v[104:107], v[52:55]
    s_waitcnt lgkmcnt(7)
    v_mfma_f32_16x16x32_bf16 v[56:59], v[68:71], v[108:111], v[56:59]
    s_waitcnt lgkmcnt(4)
    v_mfma_f32_16x16x32_bf16 v[48:51], v[72:75], v[112:115], v[48:51]
    s_waitcnt lgkmcnt(2)
    v_mfma_f32_16x16x32_bf16 v[52:55], v[72:75], v[116:119], v[52:55]
    s_waitcnt lgkmcnt(0)
    v_mfma_f32_16x16x32_bf16 v[56:59], v[72:75], v[120:123], v[56:59]
    s_waitcnt vmcnt(0)
    s_barrier
    ds_read_b128 v[60:63], v36 offset:16384
    ds_read_b64_tr_b16 v[76:77], v41 offset:24576
    ds_read_b64_tr_b16 v[78:79], v41 offset:25344
    ds_read_b64_tr_b16 v[80:81], v42 offset:24576
    ds_read_b64_tr_b16 v[82:83], v42 offset:25344
    ds_read_b64_tr_b16 v[84:85], v43 offset:24576
    ds_read_b64_tr_b16 v[86:87], v43 offset:25344
    ds_read_b128 v[64:67], v37 offset:16384
    ds_read_b64_tr_b16 v[88:89], v41 offset:30720
    ds_read_b64_tr_b16 v[90:91], v41 offset:31488
    ds_read_b64_tr_b16 v[92:93], v42 offset:30720
    ds_read_b64_tr_b16 v[94:95], v42 offset:31488
    ds_read_b64_tr_b16 v[96:97], v43 offset:30720
    ds_read_b64_tr_b16 v[98:99], v43 offset:31488
    s_waitcnt lgkmcnt(11)
    v_mfma_f32_16x16x32_bf16 v[48:51], v[60:63], v[76:79], v[48:51]
    s_waitcnt lgkmcnt(9)
    v_mfma_f32_16x16x32_bf16 v[52:55], v[60:63], v[80:83], v[52:55]
    s_waitcnt lgkmcnt(7)
    v_mfma_f32_16x16x32_bf16 v[56:59], v[60:63], v[84:87], v[56:59]
    ds_read_b128 v[68:71], v36 offset:24576
    ds_read_b64_tr_b16 v[100:101], v41 offset:36864
    ds_read_b64_tr_b16 v[102:103], v41 offset:37632
    ds_read_b64_tr_b16 v[104:105], v42 offset:36864
    ds_read_b64_tr_b16 v[106:107], v42 offset:37632
    ds_read_b64_tr_b16 v[108:109], v43 offset:36864
    ds_read_b64_tr_b16 v[110:111], v43 offset:37632
    s_waitcnt lgkmcnt(11)
    v_mfma_f32_16x16x32_bf16 v[48:51], v[64:67], v[88:91], v[48:51]
    s_waitcnt lgkmcnt(9)
    v_mfma_f32_16x16x32_bf16 v[52:55], v[64:67], v[92:95], v[52:55]
    s_waitcnt lgkmcnt(7)
    v_mfma_f32_16x16x32_bf16 v[56:59], v[64:67], v[96:99], v[56:59]
    ds_read_b128 v[72:75], v37 offset:24576
    ds_read_b64_tr_b16 v[112:113], v41 offset:43008
    ds_read_b64_tr_b16 v[114:115], v41 offset:43776
    ds_read_b64_tr_b16 v[116:117], v42 offset:43008
    ds_read_b64_tr_b16 v[118:119], v42 offset:43776
    ds_read_b64_tr_b16 v[120:121], v43 offset:43008
    ds_read_b64_tr_b16 v[122:123], v43 offset:43776
    s_waitcnt lgkmcnt(11)
    v_mfma_f32_16x16x32_bf16 v[48:51], v[68:71], v[100:103], v[48:51]
    s_waitcnt lgkmcnt(9)
    v_mfma_f32_16x16x32_bf16 v[52:55], v[68:71], v[104:107], v[52:55]
    s_waitcnt lgkmcnt(7)
    v_mfma_f32_16x16x32_bf16 v[56:59], v[68:71], v[108:111], v[56:59]
    s_waitcnt lgkmcnt(4)
    v_mfma_f32_16x16x32_bf16 v[48:51], v[72:75], v[112:115], v[48:51]
    s_waitcnt lgkmcnt(2)
    v_mfma_f32_16x16x32_bf16 v[52:55], v[72:75], v[116:119], v[52:55]
    s_waitcnt lgkmcnt(0)
    v_mfma_f32_16x16x32_bf16 v[56:59], v[72:75], v[120:123], v[56:59]
    s_nop 6
    v_cvt_pk_bf16_f32 v124, v48, v49
    v_cvt_pk_bf16_f32 v125, v50, v51
    v_cvt_pk_bf16_f32 v126, v52, v53
    v_cvt_pk_bf16_f32 v127, v54, v55
    s_nop 1
    v_permlane32_swap_b32 v124, v126
    v_permlane32_swap_b32 v125, v127
    v_cvt_pk_bf16_f32 v128, v56, v57
    v_cvt_pk_bf16_f32 v129, v58, v59
    buffer_store_dwordx4 v[124:127], v44, s[36:39], s4 offen sc1
    s_nop 0
    v_permlane32_swap_b32 v128, v130
    v_permlane32_swap_b32 v129, v131
    s_mov_b64 exec, s[94:95]
    s_nop 0
    buffer_store_dwordx4 v[128:131], v44, s[36:39], s5 offen sc1
L_P1_DONE:
    s_mov_b64 exec, 1
    s_barrier
L_NOBAR:
    s_waitcnt vmcnt(0)
    ds_add_rtn_u32 v14, v2, v3
    s_waitcnt lgkmcnt(0)
    v_readfirstlane_b32 s49, v14
    s_cmp_lg_u32 s49, 7
    s_cbranch_scc1 L_NOPUB
    buffer_store_dword v3, v45, s[96:99], 0 offen sc1
L_NOPUB:
    s_mov_b64 exec, -1
L_GL:
    ds_read_b32 v14, v2 offset:8
    s_add_u32 s64, s64, 1
    s_cmp_gt_u32 s64, 8000000
    s_cselect_b32 s50, 0xff, 0
    s_waitcnt lgkmcnt(0)
    v_readfirstlane_b32 s49, v14
    s_or_b32 s49, s49, s50
    s_lshr_b32 s49, s49, s11
    s_and_b32 s49, s49, 5
    s_andn2_b32 s8, s49, s7
    s_cbranch_scc1 L_GISSUE
    s_sleep 1
    s_branch L_GL
L_GISSUE:
    s_bitcmp1_b32 s8, 0
    s_cbranch_scc0 L_GI_1
    s_mov_b32 s50, 0
    s_mov_b32 s51, 4096
    buffer_load_dwordx4 v[32:35], v4, s[36:39], s50 offen offset:0 sc1
    buffer_load_dwordx4 v[36:39], v4, s[36:39], s50 offen offset:1024 sc1
    buffer_load_dwordx4 v[40:43], v4, s[36:39], s50 offen offset:2048 sc1
    buffer_load_dwordx4 v[44:47], v4, s[36:39], s50 offen offset:3072 sc1
    buffer_load_dwordx4 v[48:51], v4, s[36:39], s51 offen offset:0 sc1
    buffer_load_dwordx4 v[52:55], v4, s[36:39], s51 offen offset:1024 sc1
L_GI_1:
    s_bitcmp1_b32 s8, 2
    s_cbranch_scc0 L_GI_2
    s_mov_b32 s50, 24576
    s_mov_b32 s51, 28672
    buffer_load_dwordx4 v[56:59], v4, s[36:39], s50 offen offset:0 sc1
    buffer_load_dwordx4 v[60:63], v4, s[36:39], s50 offen offset:1024 sc1
    buffer_load_dwordx4 v[64:67], v4, s[36:39], s50 offen offset:2048 sc1
    buffer_load_dwordx4 v[68:71], v4, s[36:39], s50 offen offset:3072 sc1
    buffer_load_dwordx4 v[72:75], v4, s[36:39], s51 offen offset:0 sc1
    buffer_load_dwordx4 v[76:79], v4, s[36:39], s51 offen offset:1024 sc1
L_GI_2:
    s_or_b32 s7, s7, s8
    s_cmp_lg_u32 s7, 5
    s_cbranch_scc1 L_GL
    s_waitcnt vmcnt(5)
    v_dot2_f32_bf16 v80, v32, s55, 0
    v_dot2_f32_bf16 v81, v32, s56, 0
    v_dot2_f32_bf16 v82, v33, s55, 0
    v_dot2_f32_bf16 v83, v33, s56, 0
    v_dot2_f32_bf16 v84, v34, s55, 0
    v_dot2_f32_bf16 v85, v34, s56, 0
    v_dot2_f32_bf16 v86, v35, s55, 0
    v_dot2_f32_bf16 v87, v35, s56, 0
    v_dot2_f32_bf16 v80, v56, s55, v80
    v_dot2_f32_bf16 v81, v56, s56, v81
    v_dot2_f32_bf16 v82, v57, s55, v82
    v_dot2_f32_bf16 v83, v57, s56, v83
    v_dot2_f32_bf16 v84, v58, s55, v84
    v_dot2_f32_bf16 v85, v58, s56, v85
    v_dot2_f32_bf16 v86, v59, s55, v86
    v_dot2_f32_bf16 v87, v59, s56, v87
    s_waitcnt vmcnt(4)
    v_dot2_f32_bf16 v88, v36, s55, 0
    v_dot2_f32_bf16 v89, v36, s56, 0
    v_dot2_f32_bf16 v90, v37, s55, 0
    v_dot2_f32_bf16 v91, v37, s56, 0
    v_dot2_f32_bf16 v92, v38, s55, 0
    v_dot2_f32_bf16 v93, v38, s56, 0
    v_dot2_f32_bf16 v94, v39, s55, 0
    v_dot2_f32_bf16 v95, v39, s56, 0
    v_dot2_f32_bf16 v88, v60, s55, v88
    v_dot2_f32_bf16 v89, v60, s56, v89
    v_dot2_f32_bf16 v90, v61, s55, v90
    v_dot2_f32_bf16 v91, v61, s56, v91
    v_dot2_f32_bf16 v92, v62, s55, v92
    v_dot2_f32_bf16 v93, v62, s56, v93
    v_dot2_f32_bf16 v94, v63, s55, v94
    v_dot2_f32_bf16 v95, v63, s56, v95
    v_cvt_pk_bf16_f32 v96, v80, v81
    v_cvt_pk_bf16_f32 v97, v82, v83
    v_cvt_pk_bf16_f32 v98, v84, v85
    v_cvt_pk_bf16_f32 v99, v86, v87
    ds_write_b128 v5, v[96:99] offset:0
    s_waitcnt vmcnt(3)
    v_dot2_f32_bf16 v80, v40, s55, 0
    v_dot2_f32_bf16 v81, v40, s56, 0
    v_dot2_f32_bf16 v82, v41, s55, 0
    v_dot2_f32_bf16 v83, v41, s56, 0
    v_dot2_f32_bf16 v84, v42, s55, 0
    v_dot2_f32_bf16 v85, v42, s56, 0
    v_dot2_f32_bf16 v86, v43, s55, 0
    v_dot2_f32_bf16 v87, v43, s56, 0
    v_dot2_f32_bf16 v80, v64, s55, v80
    v_dot2_f32_bf16 v81, v64, s56, v81
    v_dot2_f32_bf16 v82, v65, s55, v82
    v_dot2_f32_bf16 v83, v65, s56, v83
    v_dot2_f32_bf16 v84, v66, s55, v84
    v_dot2_f32_bf16 v85, v66, s56, v85
    v_dot2_f32_bf16 v86, v67, s55, v86
    v_dot2_f32_bf16 v87, v67, s56, v87
    v_cvt_pk_bf16_f32 v100, v88, v89
    v_cvt_pk_bf16_f32 v101, v90, v91
    v_cvt_pk_bf16_f32 v102, v92, v93
    v_cvt_pk_bf16_f32 v103, v94, v95
    ds_write_b128 v5, v[100:103] offset:1024
    s_waitcnt vmcnt(2)
    v_dot2_f32_bf16 v88, v44, s55, 0
    v_dot2_f32_bf16 v89, v44, s56, 0
    v_dot2_f32_bf16 v90, v45, s55, 0
    v_dot2_f32_bf16 v91, v45, s56, 0
    v_dot2_f32_bf16 v92, v46, s55, 0
    v_dot2_f32_bf16 v93, v46, s56, 0
    v_dot2_f32_bf16 v94, v47, s55, 0
    v_dot2_f32_bf16 v95, v47, s56, 0
    v_dot2_f32_bf16 v88, v68, s55, v88
    v_dot2_f32_bf16 v89, v68, s56, v89
    v_dot2_f32_bf16 v90, v69, s55, v90
    v_dot2_f32_bf16 v91, v69, s56, v91
    v_dot2_f32_bf16 v92, v70, s55, v92
    v_dot2_f32_bf16 v93, v70, s56, v93
    v_dot2_f32_bf16 v94, v71, s55, v94
    v_dot2_f32_bf16 v95, v71, s56, v95
    v_cvt_pk_bf16_f32 v104, v80, v81
    v_cvt_pk_bf16_f32 v105, v82, v83
    v_cvt_pk_bf16_f32 v106, v84, v85
    v_cvt_pk_bf16_f32 v107, v86, v87
    ds_write_b128 v5, v[104:107] offset:2048
    s_waitcnt vmcnt(1)
    v_dot2_f32_bf16 v80, v48, s55, 0
    v_dot2_f32_bf16 v81, v48, s56, 0
    v_dot2_f32_bf16 v82, v49, s55, 0
    v_dot2_f32_bf16 v83, v49, s56, 0
    v_dot2_f32_bf16 v84, v50, s55, 0
    v_dot2_f32_bf16 v85, v50, s56, 0
    v_dot2_f32_bf16 v86, v51, s55, 0
    v_dot2_f32_bf16 v87, v51, s56, 0
    v_dot2_f32_bf16 v80, v72, s55, v80
    v_dot2_f32_bf16 v81, v72, s56, v81
    v_dot2_f32_bf16 v82, v73, s55, v82
    v_dot2_f32_bf16 v83, v73, s56, v83
    v_dot2_f32_bf16 v84, v74, s55, v84
    v_dot2_f32_bf16 v85, v74, s56, v85
    v_dot2_f32_bf16 v86, v75, s55, v86
    v_dot2_f32_bf16 v87, v75, s56, v87
    v_cvt_pk_bf16_f32 v108, v88, v89
    v_cvt_pk_bf16_f32 v109, v90, v91
    v_cvt_pk_bf16_f32 v110, v92, v93
    v_cvt_pk_bf16_f32 v111, v94, v95
    ds_write_b128 v5, v[108:111] offset:3072
    s_waitcnt vmcnt(0)
    v_dot2_f32_bf16 v88, v52, s55, 0
    v_dot2_f32_bf16 v89, v52, s56, 0
    v_dot2_f32_bf16 v90, v53, s55, 0
    v_dot2_f32_bf16 v91, v53, s56, 0
    v_dot2_f32_bf16 v92, v54, s55, 0
    v_dot2_f32_bf16 v93, v54, s56, 0
    v_dot2_f32_bf16 v94, v55, s55, 0
    v_dot2_f32_bf16 v95, v55, s56, 0
    v_dot2_f32_bf16 v88, v76, s55, v88
    v_dot2_f32_bf16 v89, v76, s56, v89
    v_dot2_f32_bf16 v90, v77, s55, v90
    v_dot2_f32_bf16 v91, v77, s56, v91
    v_dot2_f32_bf16 v92, v78, s55, v92
    v_dot2_f32_bf16 v93, v78, s56, v93
    v_dot2_f32_bf16 v94, v79, s55, v94
    v_dot2_f32_bf16 v95, v79, s56, v95
    v_cvt_pk_bf16_f32 v112, v80, v81
    v_cvt_pk_bf16_f32 v113, v82, v83
    v_cvt_pk_bf16_f32 v114, v84, v85
    v_cvt_pk_bf16_f32 v115, v86, v87
    ds_write_b128 v5, v[112:115] offset:4096
    s_nop 1
    v_cvt_pk_bf16_f32 v116, v88, v89
    v_cvt_pk_bf16_f32 v117, v90, v91
    v_cvt_pk_bf16_f32 v118, v92, v93
    v_cvt_pk_bf16_f32 v119, v94, v95
    ds_write_b128 v5, v[116:119] offset:5120
    s_waitcnt lgkmcnt(0)
    s_mov_b64 exec, 1
    ds_add_u32 v28, v3
    s_mov_b64 exec, -1
    s_mov_b32 s65, 0
L_W2:
    ds_read_b64 v[14:15], v2 offset:16
    s_add_u32 s65, s65, 1
    s_waitcnt lgkmcnt(0)
    v_readfirstlane_b32 s52, v14
    v_readfirstlane_b32 s51, v15
    s_cmp_gt_u32 s65, 8000000
    s_cbranch_scc1 L_W2_DONE
    s_cmp_ge_u32 s51, s93
    s_cselect_b32 s52, s52, 0
    s_cmp_eq_u32 s52, 4
    s_cbranch_scc1 L_W2_DONE
    s_sleep 1
    s_branch L_W2
L_W2_DONE:
    ds_read_b128 v[32:35], v16
    ds_read_b128 v[80:83], v6 offset:0
    ds_read_b128 v[84:87], v6 offset:1024
    ds_read_b128 v[36:39], v17
    ds_read_b128 v[88:91], v6 offset:2048
    ds_read_b128 v[92:95], v6 offset:3072
    ds_read_b128 v[40:43], v18
    ds_read_b128 v[96:99], v6 offset:4096
    ds_read_b128 v[100:103], v6 offset:5120
    ds_read_b128 v[44:47], v19
    ds_read_b128 v[104:107], v6 offset:6144
    s_waitcnt lgkmcnt(9)
    v_mfma_f32_32x32x16_bf16 v[108:123], v[80:83], v[32:35], 0
    ds_read_b128 v[80:83], v6 offset:7168
    ds_read_b128 v[48:51], v20
    s_waitcnt lgkmcnt(10)
    v_mfma_f32_32x32x16_bf16 v[124:139], v[84:87], v[32:35], 0
    ds_read_b128 v[84:87], v6 offset:8192
    s_waitcnt lgkmcnt(9)
    v_mfma_f32_32x32x16_bf16 v[108:123], v[88:91], v[36:39], v[108:123]
    ds_read_b128 v[88:91], v6 offset:9216
    ds_read_b128 v[52:55], v21
    s_waitcnt lgkmcnt(10)
    v_mfma_f32_32x32x16_bf16 v[124:139], v[92:95], v[36:39], v[124:139]
    ds_read_b128 v[92:95], v6 offset:10240
    s_waitcnt lgkmcnt(9)
    v_mfma_f32_32x32x16_bf16 v[108:123], v[96:99], v[40:43], v[108:123]
    ds_read_b128 v[96:99], v6 offset:11264
    ds_read_b128 v[32:35], v22
    s_waitcnt lgkmcnt(10)
    v_mfma_f32_32x32x16_bf16 v[124:139], v[100:103], v[40:43], v[124:139]
    ds_read_b128 v[100:103], v6 offset:12288
    s_waitcnt lgkmcnt(9)
    v_mfma_f32_32x32x16_bf16 v[108:123], v[104:107], v[44:47], v[108:123]
    ds_read_b128 v[104:107], v6 offset:13312
    ds_read_b128 v[36:39], v23
    s_waitcnt lgkmcnt(10)
    v_mfma_f32_32x32x16_bf16 v[124:139], v[80:83], v[44:47], v[124:139]
    ds_read_b128 v[80:83], v6 offset:14336
    s_waitcnt lgkmcnt(9)
    v_mfma_f32_32x32x16_bf16 v[108:123], v[84:87], v[48:51], v[108:123]
    ds_read_b128 v[84:87], v6 offset:15360
    ds_read_b128 v[40:43], v24
    s_waitcnt lgkmcnt(10)
    v_mfma_f32_32x32x16_bf16 v[124:139], v[88:91], v[48:51], v[124:139]
    ds_read_b128 v[88:91], v6 offset:16384
    s_waitcnt lgkmcnt(9)
    v_mfma_f32_32x32x16_bf16 v[108:123], v[92:95], v[52:55], v[108:123]
    ds_read_b128 v[92:95], v6 offset:17408
    ds_read_b128 v[44:47], v25
    s_waitcnt lgkmcnt(10)
    v_mfma_f32_32x32x16_bf16 v[124:139], v[96:99], v[52:55], v[124:139]
    ds_read_b128 v[96:99], v6 offset:18432
    s_waitcnt lgkmcnt(9)
    v_mfma_f32_32x32x16_bf16 v[108:123], v[100:103], v[32:35], v[108:123]
    ds_read_b128 v[100:103], v6 offset:19456
    ds_read_b128 v[48:51], v26
    s_waitcnt lgkmcnt(10)
    v_mfma_f32_32x32x16_bf16 v[124:139], v[104:107], v[32:35], v[124:139]
    ds_read_b128 v[104:107], v6 offset:20480
    s_waitcnt lgkmcnt(9)
    v_mfma_f32_32x32x16_bf16 v[108:123], v[80:83], v[36:39], v[108:123]
    ds_read_b128 v[80:83], v6 offset:21504
    ds_read_b128 v[52:55], v27
    s_waitcnt lgkmcnt(10)
    v_mfma_f32_32x32x16_bf16 v[124:139], v[84:87], v[36:39], v[124:139]
    ds_read_b128 v[84:87], v6 offset:22528
    s_waitcnt lgkmcnt(9)
    v_mfma_f32_32x32x16_bf16 v[108:123], v[88:91], v[40:43], v[108:123]
    ds_read_b128 v[88:91], v6 offset:23552
    s_waitcnt lgkmcnt(9)
    v_mfma_f32_32x32x16_bf16 v[124:139], v[92:95], v[40:43], v[124:139]
    s_waitcnt lgkmcnt(7)
    v_mfma_f32_32x32x16_bf16 v[108:123], v[96:99], v[44:47], v[108:123]
    s_waitcnt lgkmcnt(6)
    v_mfma_f32_32x32x16_bf16 v[124:139], v[100:103], v[44:47], v[124:139]
    s_waitcnt lgkmcnt(4)
    v_mfma_f32_32x32x16_bf16 v[108:123], v[104:107], v[48:51], v[108:123]
    s_waitcnt lgkmcnt(3)
    v_mfma_f32_32x32x16_bf16 v[124:139], v[80:83], v[48:51], v[124:139]
    s_waitcnt lgkmcnt(1)
    v_mfma_f32_32x32x16_bf16 v[108:123], v[84:87], v[52:55], v[108:123]
    s_waitcnt lgkmcnt(0)
    v_mfma_f32_32x32x16_bf16 v[124:139], v[88:91], v[52:55], v[124:139]
    s_nop 7
    s_nop 1
    v_max3_f32 v156, v108, v109, v110
    v_max3_f32 v157, v111, v112, v113
    v_max3_f32 v156, v156, v114, v115
    v_max3_f32 v157, v157, v116, v117
    v_max3_f32 v156, v156, v118, v119
    v_max3_f32 v157, v157, v120, v121
    v_max3_f32 v156, v156, v122, v123
    v_max3_f32 v157, v157, v124, v125
    v_max3_f32 v156, v156, v126, v127
    v_max3_f32 v157, v157, v128, v129
    v_max3_f32 v156, v156, v130, v131
    v_max3_f32 v157, v157, v132, v133
    v_max3_f32 v156, v156, v134, v135
    v_max3_f32 v157, v157, v136, v137
    v_max3_f32 v156, v156, v138, v139
    v_max_f32 v156, v156, v157
    v_mov_b32 v157, v156
    s_nop 1
    v_permlane32_swap_b32 v156, v157
    s_nop 1
    v_max_f32 v156, v156, v157
    v_mul_f32 v156, s57, v156
    s_mov_b32 s50, s57
    s_mov_b32 s51, s57
    v_pk_fma_f32 v[108:109], v[108:109], s[50:51], v[156:157] op_sel_hi:[1,1,0] neg_lo:[0,0,1] neg_hi:[0,0,1]
    v_pk_fma_f32 v[110:111], v[110:111], s[50:51], v[156:157] op_sel_hi:[1,1,0] neg_lo:[0,0,1] neg_hi:[0,0,1]
    v_pk_fma_f32 v[112:113], v[112:113], s[50:51], v[156:157] op_sel_hi:[1,1,0] neg_lo:[0,0,1] neg_hi:[0,0,1]
    v_pk_fma_f32 v[114:115], v[114:115], s[50:51], v[156:157] op_sel_hi:[1,1,0] neg_lo:[0,0,1] neg_hi:[0,0,1]
    v_pk_fma_f32 v[116:117], v[116:117], s[50:51], v[156:157] op_sel_hi:[1,1,0] neg_lo:[0,0,1] neg_hi:[0,0,1]
    v_pk_fma_f32 v[118:119], v[118:119], s[50:51], v[156:157] op_sel_hi:[1,1,0] neg_lo:[0,0,1] neg_hi:[0,0,1]
    v_pk_fma_f32 v[120:121], v[120:121], s[50:51], v[156:157] op_sel_hi:[1,1,0] neg_lo:[0,0,1] neg_hi:[0,0,1]
    v_pk_fma_f32 v[122:123], v[122:123], s[50:51], v[156:157] op_sel_hi:[1,1,0] neg_lo:[0,0,1] neg_hi:[0,0,1]
    v_pk_fma_f32 v[124:125], v[124:125], s[50:51], v[156:157] op_sel_hi:[1,1,0] neg_lo:[0,0,1] neg_hi:[0,0,1]
    v_pk_fma_f32 v[126:127], v[126:127], s[50:51], v[156:157] op_sel_hi:[1,1,0] neg_lo:[0,0,1] neg_hi:[0,0,1]
    v_pk_fma_f32 v[128:129], v[128:129], s[50:51], v[156:157] op_sel_hi:[1,1,0] neg_lo:[0,0,1] neg_hi:[0,0,1]
    v_pk_fma_f32 v[130:131], v[130:131], s[50:51], v[156:157] op_sel_hi:[1,1,0] neg_lo:[0,0,1] neg_hi:[0,0,1]
    v_pk_fma_f32 v[132:133], v[132:133], s[50:51], v[156:157] op_sel_hi:[1,1,0] neg_lo:[0,0,1] neg_hi:[0,0,1]
    v_pk_fma_f32 v[134:135], v[134:135], s[50:51], v[156:157] op_sel_hi:[1,1,0] neg_lo:[0,0,1] neg_hi:[0,0,1]
    v_pk_fma_f32 v[136:137], v[136:137], s[50:51], v[156:157] op_sel_hi:[1,1,0] neg_lo:[0,0,1] neg_hi:[0,0,1]
    v_pk_fma_f32 v[138:139], v[138:139], s[50:51], v[156:157] op_sel_hi:[1,1,0] neg_lo:[0,0,1] neg_hi:[0,0,1]
    v_exp_f32 v108, v108
    v_exp_f32 v109, v109
    v_exp_f32 v110, v110
    v_exp_f32 v111, v111
    v_exp_f32 v112, v112
    v_exp_f32 v113, v113
    v_exp_f32 v114, v114
    v_exp_f32 v115, v115
    v_exp_f32 v116, v116
    v_exp_f32 v117, v117
    v_exp_f32 v118, v118
    v_exp_f32 v119, v119
    v_exp_f32 v120, v120
    v_exp_f32 v121, v121
    v_exp_f32 v122, v122
    v_exp_f32 v123, v123
    v_exp_f32 v124, v124
    v_exp_f32 v125, v125
    v_exp_f32 v126, v126
    v_exp_f32 v127, v127
    v_exp_f32 v128, v128
    v_exp_f32 v129, v129
    v_exp_f32 v130, v130
    v_exp_f32 v131, v131
    v_exp_f32 v132, v132
    v_exp_f32 v133, v133
    v_exp_f32 v134, v134
    v_exp_f32 v135, v135
    v_exp_f32 v136, v136
    v_exp_f32 v137, v137
    v_exp_f32 v138, v138
    v_exp_f32 v139, v139
    s_nop 0
    v_pk_add_f32 v[158:159], v[108:109], v[110:111]
    v_pk_add_f32 v[156:157], v[112:113], v[114:115]
    v_pk_add_f32 v[158:159], v[158:159], v[116:117]
    v_pk_add_f32 v[156:157], v[156:157], v[118:119]
    v_pk_add_f32 v[158:159], v[158:159], v[120:121]
    v_pk_add_f32 v[156:157], v[156:157], v[122:123]
    v_pk_add_f32 v[158:159], v[158:159], v[124:125]
    v_pk_add_f32 v[156:157], v[156:157], v[126:127]
    v_pk_add_f32 v[158:159], v[158:159], v[128:129]
    v_pk_add_f32 v[156:157], v[156:157], v[130:131]
    v_pk_add_f32 v[158:159], v[158:159], v[132:133]
    v_pk_add_f32 v[156:157], v[156:157], v[134:135]
    v_pk_add_f32 v[158:159], v[158:159], v[136:137]
    v_pk_add_f32 v[156:157], v[156:157], v[138:139]
    v_pk_add_f32 v[158:159], v[158:159], v[156:157]
    ds_read_b32 v14, v2 offset:24
    v_add_f32 v158, v158, v159
    v_mov_b32 v159, v158
    s_nop 1
    v_permlane32_swap_b32 v158, v159
    s_nop 1
    v_add_f32 v158, v158, v159
    v_rcp_f32 v158, v158
    s_mov_b32 s65, 0
    s_waitcnt lgkmcnt(0)
    v_readfirstlane_b32 s49, v14
    s_cmp_eq_u32 s49, 4
    s_cbranch_scc1 L_W3_DONE
L_W3:
    ds_read_b32 v14, v2 offset:24
    s_add_u32 s65, s65, 1
    s_waitcnt lgkmcnt(0)
    v_readfirstlane_b32 s49, v14
    s_cmp_eq_u32 s49, 4
    s_cbranch_scc1 L_W3_DONE
    s_cmp_gt_u32 s65, 8000000
    s_cbranch_scc0 L_W3
L_W3_DONE:
    ds_read_b128 v[32:35], v6 offset:24576
    ds_read_b128 v[36:39], v6 offset:28672
    ds_read_b128 v[40:43], v6 offset:25600
    ds_read_b128 v[44:47], v6 offset:29696
    ds_read_b128 v[48:51], v6 offset:26624
    ds_read_b128 v[52:55], v6 offset:30720
    ds_read_b128 v[56:59], v6 offset:27648
    v_pk_mul_f32 v[108:109], v[108:109], v[158:159] op_sel_hi:[1,0]
    v_pk_mul_f32 v[110:111], v[110:111], v[158:159] op_sel_hi:[1,0]
    v_pk_mul_f32 v[112:113], v[112:113], v[158:159] op_sel_hi:[1,0]
    v_pk_mul_f32 v[114:115], v[114:115], v[158:159] op_sel_hi:[1,0]
    v_pk_mul_f32 v[116:117], v[116:117], v[158:159] op_sel_hi:[1,0]
    v_pk_mul_f32 v[118:119], v[118:119], v[158:159] op_sel_hi:[1,0]
    v_pk_mul_f32 v[120:121], v[120:121], v[158:159] op_sel_hi:[1,0]
    v_pk_mul_f32 v[122:123], v[122:123], v[158:159] op_sel_hi:[1,0]
    v_pk_mul_f32 v[124:125], v[124:125], v[158:159] op_sel_hi:[1,0]
    v_pk_mul_f32 v[126:127], v[126:127], v[158:159] op_sel_hi:[1,0]
    v_pk_mul_f32 v[128:129], v[128:129], v[158:159] op_sel_hi:[1,0]
    v_pk_mul_f32 v[130:131], v[130:131], v[158:159] op_sel_hi:[1,0]
    v_pk_mul_f32 v[132:133], v[132:133], v[158:159] op_sel_hi:[1,0]
    v_pk_mul_f32 v[134:135], v[134:135], v[158:159] op_sel_hi:[1,0]
    v_pk_mul_f32 v[136:137], v[136:137], v[158:159] op_sel_hi:[1,0]
    v_pk_mul_f32 v[138:139], v[138:139], v[158:159] op_sel_hi:[1,0]
    v_cvt_pk_bf16_f32 v140, v108, v109
    v_cvt_pk_bf16_f32 v141, v110, v111
    v_cvt_pk_bf16_f32 v142, v112, v113
    v_cvt_pk_bf16_f32 v143, v114, v115
    v_cvt_pk_bf16_f32 v144, v116, v117
    v_cvt_pk_bf16_f32 v145, v118, v119
    v_cvt_pk_bf16_f32 v146, v120, v121
    v_cvt_pk_bf16_f32 v147, v122, v123
    v_cvt_pk_bf16_f32 v148, v124, v125
    v_cvt_pk_bf16_f32 v149, v126, v127
    v_cvt_pk_bf16_f32 v150, v128, v129
    v_cvt_pk_bf16_f32 v151, v130, v131
    v_cvt_pk_bf16_f32 v152, v132, v133
    v_cvt_pk_bf16_f32 v153, v134, v135
    v_cvt_pk_bf16_f32 v154, v136, v137
    v_cvt_pk_bf16_f32 v155, v138, v139
    s_nop 1
    s_waitcnt lgkmcnt(6)
    v_mfma_f32_32x32x16_bf16 v[60:75], v[32:35], v[140:143], 0
    ds_read_b128 v[32:35], v6 offset:31744
    s_waitcnt lgkmcnt(6)
    v_mfma_f32_32x32x16_bf16 v[76:91], v[36:39], v[140:143], 0
    ds_read_b128 v[36:39], v6 offset:32768
    s_waitcnt lgkmcnt(6)
    v_mfma_f32_32x32x16_bf16 v[60:75], v[40:43], v[144:147], v[60:75]
    ds_read_b128 v[40:43], v6 offset:36864
    s_waitcnt lgkmcnt(6)
    v_mfma_f32_32x32x16_bf16 v[76:91], v[44:47], v[144:147], v[76:91]
    ds_read_b128 v[44:47], v6 offset:33792
    s_waitcnt lgkmcnt(6)
    v_mfma_f32_32x32x16_bf16 v[60:75], v[48:51], v[148:151], v[60:75]
    ds_read_b128 v[48:51], v6 offset:37888
    s_waitcnt lgkmcnt(6)
    v_mfma_f32_32x32x16_bf16 v[76:91], v[52:55], v[148:151], v[76:91]
    ds_read_b128 v[52:55], v6 offset:34816
    s_waitcnt lgkmcnt(6)
    v_mfma_f32_32x32x16_bf16 v[60:75], v[56:59], v[152:155], v[60:75]
    ds_read_b128 v[56:59], v6 offset:38912
    s_waitcnt lgkmcnt(6)
    v_mfma_f32_32x32x16_bf16 v[76:91], v[32:35], v[152:155], v[76:91]
    ds_read_b128 v[32:35], v6 offset:35840
    s_waitcnt lgkmcnt(6)
    v_mfma_f32_32x32x16_bf16 v[92:107], v[36:39], v[140:143], 0
    ds_read_b128 v[36:39], v6 offset:39936
    s_waitcnt lgkmcnt(6)
    v_mfma_f32_32x32x16_bf16 v[108:123], v[40:43], v[140:143], 0
    ds_read_b128 v[40:43], v6 offset:40960
    s_nop 7
    s_nop 1
    v_cvt_pk_bf16_f32 v124, v60, v61
    v_cvt_pk_bf16_f32 v125, v62, v63
    v_cvt_pk_bf16_f32 v126, v64, v65
    v_cvt_pk_bf16_f32 v127, v66, v67
    ds_write_b128 v9, v[124:127] offset:0
    v_cvt_pk_bf16_f32 v128, v68, v69
    v_cvt_pk_bf16_f32 v129, v70, v71
    v_cvt_pk_bf16_f32 v130, v72, v73
    v_cvt_pk_bf16_f32 v131, v74, v75
    ds_write_b128 v10, v[128:131] offset:0
    v_cvt_pk_bf16_f32 v132, v76, v77
    v_cvt_pk_bf16_f32 v133, v78, v79
    v_cvt_pk_bf16_f32 v134, v80, v81
    v_cvt_pk_bf16_f32 v135, v82, v83
    ds_write_b128 v11, v[132:135] offset:0
    v_cvt_pk_bf16_f32 v136, v84, v85
    v_cvt_pk_bf16_f32 v137, v86, v87
    v_cvt_pk_bf16_f32 v138, v88, v89
    v_cvt_pk_bf16_f32 v139, v90, v91
    ds_write_b128 v12, v[136:139] offset:0
    ds_read_b128 v[124:127], v7 offset:0
    ds_read_b128 v[128:131], v7 offset:3072
    ds_read_b128 v[132:135], v7 offset:6144
    ds_read_b128 v[136:139], v7 offset:9216
    s_waitcnt lgkmcnt(14)
    v_mfma_f32_32x32x16_bf16 v[92:107], v[44:47], v[144:147], v[92:107]
    ds_read_b128 v[44:47], v6 offset:45056
    s_waitcnt lgkmcnt(14)
    v_mfma_f32_32x32x16_bf16 v[108:123], v[48:51], v[144:147], v[108:123]
    ds_read_b128 v[48:51], v6 offset:41984
    s_waitcnt lgkmcnt(14)
    v_mfma_f32_32x32x16_bf16 v[92:107], v[52:55], v[148:151], v[92:107]
    ds_read_b128 v[52:55], v6 offset:46080
    s_waitcnt lgkmcnt(6)
    buffer_store_dwordx4 v[124:127], v8, s[32:35], s58 offen offset:0 sc1
    s_waitcnt lgkmcnt(5)
    buffer_store_dwordx4 v[128:131], v8, s[32:35], s59 offen offset:0 sc1
    s_waitcnt lgkmcnt(4)
    buffer_store_dwordx4 v[132:135], v8, s[32:35], s60 offen offset:0 sc1
    s_waitcnt lgkmcnt(3)
    buffer_store_dwordx4 v[136:139], v8, s[32:35], s61 offen offset:0 sc1
    v_mfma_f32_32x32x16_bf16 v[108:123], v[56:59], v[148:151], v[108:123]
    ds_read_b128 v[56:59], v6 offset:43008
    v_mfma_f32_32x32x16_bf16 v[92:107], v[32:35], v[152:155], v[92:107]
    ds_read_b128 v[32:35], v6 offset:47104
    v_mfma_f32_32x32x16_bf16 v[108:123], v[36:39], v[152:155], v[108:123]
    ds_read_b128 v[36:39], v6 offset:44032
    v_mfma_f32_32x32x16_bf16 v[60:75], v[40:43], v[140:143], 0
    ds_read_b128 v[40:43], v6 offset:48128
    s_waitcnt lgkmcnt(6)
    v_mfma_f32_32x32x16_bf16 v[76:91], v[44:47], v[140:143], 0
    s_nop 7
    s_nop 1
    v_cvt_pk_bf16_f32 v16, v92, v93
    v_cvt_pk_bf16_f32 v17, v94, v95
    v_cvt_pk_bf16_f32 v18, v96, v97
    v_cvt_pk_bf16_f32 v19, v98, v99
    ds_write_b128 v9, v[16:19] offset:128
    v_cvt_pk_bf16_f32 v20, v100, v101
    v_cvt_pk_bf16_f32 v21, v102, v103
    v_cvt_pk_bf16_f32 v22, v104, v105
    v_cvt_pk_bf16_f32 v23, v106, v107
    ds_write_b128 v10, v[20:23] offset:128
    v_cvt_pk_bf16_f32 v24, v108, v109
    v_cvt_pk_bf16_f32 v25, v110, v111
    v_cvt_pk_bf16_f32 v26, v112, v113
    v_cvt_pk_bf16_f32 v27, v114, v115
    ds_write_b128 v11, v[24:27] offset:128
    v_cvt_pk_bf16_f32 v28, v116, v117
    v_cvt_pk_bf16_f32 v29, v118, v119
    v_cvt_pk_bf16_f32 v30, v120, v121
    v_cvt_pk_bf16_f32 v31, v122, v123
    ds_write_b128 v12, v[28:31] offset:128
    ds_read_b128 v[16:19], v7 offset:128
    ds_read_b128 v[20:23], v7 offset:3200
    ds_read_b128 v[24:27], v7 offset:6272
    ds_read_b128 v[28:31], v7 offset:9344
    s_waitcnt lgkmcnt(13)
    v_mfma_f32_32x32x16_bf16 v[60:75], v[48:51], v[144:147], v[60:75]
    s_waitcnt lgkmcnt(12)
    v_mfma_f32_32x32x16_bf16 v[76:91], v[52:55], v[144:147], v[76:91]
    s_waitcnt lgkmcnt(11)
    v_mfma_f32_32x32x16_bf16 v[60:75], v[56:59], v[148:151], v[60:75]
    s_waitcnt lgkmcnt(3)
    buffer_store_dwordx4 v[16:19], v8, s[32:35], s58 offen offset:128 sc1
    s_waitcnt lgkmcnt(2)
    buffer_store_dwordx4 v[20:23], v8, s[32:35], s59 offen offset:128 sc1
    s_waitcnt lgkmcnt(1)
    buffer_store_dwordx4 v[24:27], v8, s[32:35], s60 offen offset:128 sc1
    s_waitcnt lgkmcnt(0)
    buffer_store_dwordx4 v[28:31], v8, s[32:35], s61 offen offset:128 sc1
    v_mfma_f32_32x32x16_bf16 v[76:91], v[32:35], v[148:151], v[76:91]
    v_mfma_f32_32x32x16_bf16 v[60:75], v[36:39], v[152:155], v[60:75]
    v_mfma_f32_32x32x16_bf16 v[76:91], v[40:43], v[152:155], v[76:91]
    s_nop 7
    s_nop 3
    v_cvt_pk_bf16_f32 v124, v60, v61
    v_cvt_pk_bf16_f32 v125, v62, v63
    v_cvt_pk_bf16_f32 v126, v64, v65
    v_cvt_pk_bf16_f32 v127, v66, v67
    ds_write_b128 v9, v[124:127] offset:256
    v_cvt_pk_bf16_f32 v128, v68, v69
    v_cvt_pk_bf16_f32 v129, v70, v71
    v_cvt_pk_bf16_f32 v130, v72, v73
    v_cvt_pk_bf16_f32 v131, v74, v75
    ds_write_b128 v10, v[128:131] offset:256
    v_cvt_pk_bf16_f32 v132, v76, v77
    v_cvt_pk_bf16_f32 v133, v78, v79
    v_cvt_pk_bf16_f32 v134, v80, v81
    v_cvt_pk_bf16_f32 v135, v82, v83
    ds_write_b128 v11, v[132:135] offset:256
    v_cvt_pk_bf16_f32 v136, v84, v85
    v_cvt_pk_bf16_f32 v137, v86, v87
    v_cvt_pk_bf16_f32 v138, v88, v89
    v_cvt_pk_bf16_f32 v139, v90, v91
    ds_write_b128 v12, v[136:139] offset:256
    ds_read_b128 v[124:127], v7 offset:256
    ds_read_b128 v[128:131], v7 offset:3328
    ds_read_b128 v[132:135], v7 offset:6400
    ds_read_b128 v[136:139], v7 offset:9472
    s_waitcnt lgkmcnt(3)
    buffer_store_dwordx4 v[124:127], v8, s[32:35], s58 offen offset:256 sc1
    s_waitcnt lgkmcnt(2)
    buffer_store_dwordx4 v[128:131], v8, s[32:35], s59 offen offset:256 sc1
    s_waitcnt lgkmcnt(1)
    buffer_store_dwordx4 v[132:135], v8, s[32:35], s60 offen offset:256 sc1
    s_waitcnt lgkmcnt(0)
    buffer_store_dwordx4 v[136:139], v8, s[32:35], s61 offen offset:256 sc1
    s_endpgm
L_HELP:
    v_mov_b32 v2, 147456
    v_mov_b32 v3, 1
    s_mov_b32 s64, 0
    v_lshrrev_b32 v132, 3, v1
    v_and_b32 v136, 7, v1
    v_lshrrev_b32 v134, 4, v1
    v_xor_b32 v135, v134, v136
    v_lshlrev_b32 v135, 4, v135
    v_lshl_add_u32 v36, v132, 7, v135
    v_xor_b32 v37, 64, v36
    s_mul_i32 s50, s46, 98304
    s_add_u32 s50, s50, s49
    s_mov_b32 s30, 98304
    s_mov_b32 s31, 0x00020000
    s_waitcnt lgkmcnt(0)
    s_add_u32 s28, s4, s50
    s_addc_u32 s29, s5, 0
    s_cmp_eq_u32 s44, 8
    s_cbranch_scc0 L_POLLER
    v_lshlrev_b32 v134, 2, v1
    v_add_u32 v134, 147456, v134
    v_mov_b32 v135, 0
    ds_write_b32 v134, v135
    s_waitcnt lgkmcnt(0)
    s_barrier
    s_barrier
    s_barrier
    s_barrier
    s_barrier
    s_barrier
    s_barrier
    s_barrier
    s_barrier
    s_mov_b32 s52, 0
    s_mov_b32 m0, s52
    s_nop 0
    buffer_load_dwordx4 v36, s[28:31], s52 offen offset:0 nt lds
    buffer_load_dwordx4 v37, s[28:31], s52 offen offset:1024 nt lds
    buffer_load_dwordx4 v36, s[28:31], s52 offen offset:2048 nt lds
    buffer_load_dwordx4 v37, s[28:31], s52 offen offset:3072 nt lds
    s_mov_b32 s52, 4096
    s_mov_b32 m0, s52
    s_nop 0
    buffer_load_dwordx4 v36, s[28:31], s52 offen offset:0 nt lds
    buffer_load_dwordx4 v37, s[28:31], s52 offen offset:1024 nt lds
    buffer_load_dwordx4 v36, s[28:31], s52 offen offset:2048 nt lds
    buffer_load_dwordx4 v37, s[28:31], s52 offen offset:3072 nt lds
    s_mov_b32 s52, 8192
    s_mov_b32 m0, s52
    s_nop 0
    buffer_load_dwordx4 v36, s[28:31], s52 offen offset:0 nt lds
    buffer_load_dwordx4 v37, s[28:31], s52 offen offset:1024 nt lds
    buffer_load_dwordx4 v36, s[28:31], s52 offen offset:2048 nt lds
    buffer_load_dwordx4 v37, s[28:31], s52 offen offset:3072 nt lds
    s_mov_b32 s52, 12288
    s_mov_b32 m0, s52
    s_nop 0
    buffer_load_dwordx4 v36, s[28:31], s52 offen offset:0 nt lds
    buffer_load_dwordx4 v37, s[28:31], s52 offen offset:1024 nt lds
    buffer_load_dwordx4 v36, s[28:31], s52 offen offset:2048 nt lds
    buffer_load_dwordx4 v37, s[28:31], s52 offen offset:3072 nt lds
    s_mov_b32 s52, 16384
    s_mov_b32 m0, s52
    s_nop 0
    buffer_load_dwordx4 v36, s[28:31], s52 offen offset:0 nt lds
    buffer_load_dwordx4 v37, s[28:31], s52 offen offset:1024 nt lds
    buffer_load_dwordx4 v36, s[28:31], s52 offen offset:2048 nt lds
    buffer_load_dwordx4 v37, s[28:31], s52 offen offset:3072 nt lds
    s_mov_b32 s52, 20480
    s_mov_b32 m0, s52
    s_nop 0
    buffer_load_dwordx4 v36, s[28:31], s52 offen offset:0 nt lds
    buffer_load_dwordx4 v37, s[28:31], s52 offen offset:1024 nt lds
    buffer_load_dwordx4 v36, s[28:31], s52 offen offset:2048 nt lds
    buffer_load_dwordx4 v37, s[28:31], s52 offen offset:3072 nt lds
    s_barrier
    s_barrier
    s_barrier
    s_waitcnt lgkmcnt(0)
    s_waitcnt vmcnt(23)
    s_mov_b32 s52, 24576
    s_mov_b32 m0, s52
    s_nop 0
    buffer_load_dwordx4 v36, s[28:31], s52 offen offset:0 nt lds
    s_waitcnt vmcnt(23)
    buffer_load_dwordx4 v37, s[28:31], s52 offen offset:1024 nt lds
    s_waitcnt vmcnt(23)
    buffer_load_dwordx4 v36, s[28:31], s52 offen offset:2048 nt lds
    s_waitcnt vmcnt(23)
    buffer_load_dwordx4 v37, s[28:31], s52 offen offset:3072 nt lds
    s_waitcnt vmcnt(23)
    s_mov_b32 s52, 28672
    s_mov_b32 m0, s52
    s_nop 0
    buffer_load_dwordx4 v36, s[28:31], s52 offen offset:0 nt lds
    s_waitcnt vmcnt(23)
    buffer_load_dwordx4 v37, s[28:31], s52 offen offset:1024 nt lds
    s_waitcnt vmcnt(23)
    buffer_load_dwordx4 v36, s[28:31], s52 offen offset:2048 nt lds
    s_waitcnt vmcnt(23)
    buffer_load_dwordx4 v37, s[28:31], s52 offen offset:3072 nt lds
    s_waitcnt vmcnt(23)
    s_mov_b32 s52, 32768
    s_mov_b32 m0, s52
    s_nop 0
    buffer_load_dwordx4 v36, s[28:31], s52 offen offset:0 nt lds
    s_waitcnt vmcnt(23)
    buffer_load_dwordx4 v37, s[28:31], s52 offen offset:1024 nt lds
    s_waitcnt vmcnt(23)
    buffer_load_dwordx4 v36, s[28:31], s52 offen offset:2048 nt lds
    s_waitcnt vmcnt(23)
    v_mov_b32 v14, 12
    ds_write_b32 v2, v14 offset:20
    buffer_load_dwordx4 v37, s[28:31], s52 offen offset:3072 nt lds
    s_waitcnt vmcnt(23)
    s_mov_b32 s52, 36864
    s_mov_b32 m0, s52
    s_nop 0
    buffer_load_dwordx4 v36, s[28:31], s52 offen offset:0 nt lds
    s_waitcnt vmcnt(23)
    buffer_load_dwordx4 v37, s[28:31], s52 offen offset:1024 nt lds
    s_waitcnt vmcnt(23)
    buffer_load_dwordx4 v36, s[28:31], s52 offen offset:2048 nt lds
    s_waitcnt vmcnt(23)
    buffer_load_dwordx4 v37, s[28:31], s52 offen offset:3072 nt lds
    s_waitcnt vmcnt(23)
    s_mov_b32 s52, 40960
    s_mov_b32 m0, s52
    s_nop 0
    buffer_load_dwordx4 v36, s[28:31], s52 offen offset:0 nt lds
    s_waitcnt vmcnt(23)
    buffer_load_dwordx4 v37, s[28:31], s52 offen offset:1024 nt lds
    s_waitcnt vmcnt(23)
    buffer_load_dwordx4 v36, s[28:31], s52 offen offset:2048 nt lds
    s_waitcnt vmcnt(23)
    buffer_load_dwordx4 v37, s[28:31], s52 offen offset:3072 nt lds
    s_waitcnt vmcnt(23)
    s_mov_b32 s52, 45056
    s_mov_b32 m0, s52
    s_nop 0
    buffer_load_dwordx4 v36, s[28:31], s52 offen offset:0 nt lds
    s_waitcnt vmcnt(23)
    buffer_load_dwordx4 v37, s[28:31], s52 offen offset:1024 nt lds
    s_waitcnt vmcnt(23)
    buffer_load_dwordx4 v36, s[28:31], s52 offen offset:2048 nt lds
    s_waitcnt vmcnt(23)
    v_mov_b32 v14, 24
    ds_write_b32 v2, v14 offset:20
    buffer_load_dwordx4 v37, s[28:31], s52 offen offset:3072 nt lds
    s_waitcnt vmcnt(23)
    s_mov_b32 s52, 49152
    s_mov_b32 m0, s52
    s_nop 0
    buffer_load_dwordx4 v36, s[28:31], s52 offen offset:0 nt lds
    s_waitcnt vmcnt(23)
    buffer_load_dwordx4 v37, s[28:31], s52 offen offset:1024 nt lds
    s_waitcnt vmcnt(23)
    buffer_load_dwordx4 v36, s[28:31], s52 offen offset:2048 nt lds
    s_waitcnt vmcnt(23)
    buffer_load_dwordx4 v37, s[28:31], s52 offen offset:3072 nt lds
    s_waitcnt vmcnt(23)
    s_mov_b32 s52, 53248
    s_mov_b32 m0, s52
    s_nop 0
    buffer_load_dwordx4 v36, s[28:31], s52 offen offset:0 nt lds
    s_waitcnt vmcnt(23)
    buffer_load_dwordx4 v37, s[28:31], s52 offen offset:1024 nt lds
    s_waitcnt vmcnt(23)
    buffer_load_dwordx4 v36, s[28:31], s52 offen offset:2048 nt lds
    s_waitcnt vmcnt(23)
    buffer_load_dwordx4 v37, s[28:31], s52 offen offset:3072 nt lds
    s_waitcnt vmcnt(23)
    s_mov_b32 s52, 57344
    s_mov_b32 m0, s52
    s_nop 0
    buffer_load_dwordx4 v36, s[28:31], s52 offen offset:0 nt lds
    s_waitcnt vmcnt(23)
    buffer_load_dwordx4 v37, s[28:31], s52 offen offset:1024 nt lds
    s_waitcnt vmcnt(23)
    buffer_load_dwordx4 v36, s[28:31], s52 offen offset:2048 nt lds
    s_waitcnt vmcnt(23)
    v_mov_b32 v14, 36
    ds_write_b32 v2, v14 offset:20
    buffer_load_dwordx4 v37, s[28:31], s52 offen offset:3072 nt lds
    s_waitcnt vmcnt(23)
    s_mov_b32 s52, 61440
    s_mov_b32 m0, s52
    s_nop 0
    buffer_load_dwordx4 v36, s[28:31], s52 offen offset:0 nt lds
    s_waitcnt vmcnt(23)
    buffer_load_dwordx4 v37, s[28:31], s52 offen offset:1024 nt lds
    s_waitcnt vmcnt(23)
    buffer_load_dwordx4 v36, s[28:31], s52 offen offset:2048 nt lds
    s_waitcnt vmcnt(23)
    buffer_load_dwordx4 v37, s[28:31], s52 offen offset:3072 nt lds
    s_waitcnt vmcnt(23)
    s_mov_b32 s52, 65536
    s_mov_b32 m0, s52
    s_nop 0
    buffer_load_dwordx4 v36, s[28:31], s52 offen offset:0 nt lds
    s_waitcnt vmcnt(23)
    buffer_load_dwordx4 v37, s[28:31], s52 offen offset:1024 nt lds
    s_waitcnt vmcnt(23)
    buffer_load_dwordx4 v36, s[28:31], s52 offen offset:2048 nt lds
    s_waitcnt vmcnt(23)
    buffer_load_dwordx4 v37, s[28:31], s52 offen offset:3072 nt lds
    s_waitcnt vmcnt(23)
    s_mov_b32 s52, 69632
    s_mov_b32 m0, s52
    s_nop 0
    buffer_load_dwordx4 v36, s[28:31], s52 offen offset:0 nt lds
    s_waitcnt vmcnt(23)
    buffer_load_dwordx4 v37, s[28:31], s52 offen offset:1024 nt lds
    s_waitcnt vmcnt(23)
    buffer_load_dwordx4 v36, s[28:31], s52 offen offset:2048 nt lds
    s_waitcnt vmcnt(23)
    v_mov_b32 v14, 48
    ds_write_b32 v2, v14 offset:20
    buffer_load_dwordx4 v37, s[28:31], s52 offen offset:3072 nt lds
    s_waitcnt vmcnt(23)
    s_mov_b32 s52, 73728
    s_mov_b32 m0, s52
    s_nop 0
    buffer_load_dwordx4 v36, s[28:31], s52 offen offset:0 nt lds
    s_waitcnt vmcnt(23)
    buffer_load_dwordx4 v37, s[28:31], s52 offen offset:1024 nt lds
    s_waitcnt vmcnt(23)
    buffer_load_dwordx4 v36, s[28:31], s52 offen offset:2048 nt lds
    s_waitcnt vmcnt(23)
    buffer_load_dwordx4 v37, s[28:31], s52 offen offset:3072 nt lds
    s_waitcnt vmcnt(23)
    s_mov_b32 s52, 77824
    s_mov_b32 m0, s52
    s_nop 0
    buffer_load_dwordx4 v36, s[28:31], s52 offen offset:0 nt lds
    s_waitcnt vmcnt(23)
    buffer_load_dwordx4 v37, s[28:31], s52 offen offset:1024 nt lds
    s_waitcnt vmcnt(23)
    buffer_load_dwordx4 v36, s[28:31], s52 offen offset:2048 nt lds
    s_waitcnt vmcnt(23)
    buffer_load_dwordx4 v37, s[28:31], s52 offen offset:3072 nt lds
    s_waitcnt vmcnt(23)
    s_mov_b32 s52, 81920
    s_mov_b32 m0, s52
    s_nop 0
    buffer_load_dwordx4 v36, s[28:31], s52 offen offset:0 nt lds
    s_waitcnt vmcnt(23)
    buffer_load_dwordx4 v37, s[28:31], s52 offen offset:1024 nt lds
    s_waitcnt vmcnt(23)
    buffer_load_dwordx4 v36, s[28:31], s52 offen offset:2048 nt lds
    s_waitcnt vmcnt(23)
    v_mov_b32 v14, 60
    ds_write_b32 v2, v14 offset:20
    buffer_load_dwordx4 v37, s[28:31], s52 offen offset:3072 nt lds
    s_waitcnt vmcnt(23)
    s_mov_b32 s52, 86016
    s_mov_b32 m0, s52
    s_nop 0
    buffer_load_dwordx4 v36, s[28:31], s52 offen offset:0 nt lds
    s_waitcnt vmcnt(23)
    buffer_load_dwordx4 v37, s[28:31], s52 offen offset:1024 nt lds
    s_waitcnt vmcnt(23)
    buffer_load_dwordx4 v36, s[28:31], s52 offen offset:2048 nt lds
    s_waitcnt vmcnt(23)
    buffer_load_dwordx4 v37, s[28:31], s52 offen offset:3072 nt lds
    s_waitcnt vmcnt(23)
    s_mov_b32 s52, 90112
    s_mov_b32 m0, s52
    s_nop 0
    buffer_load_dwordx4 v36, s[28:31], s52 offen offset:0 nt lds
    s_waitcnt vmcnt(23)
    buffer_load_dwordx4 v37, s[28:31], s52 offen offset:1024 nt lds
    s_waitcnt vmcnt(23)
    buffer_load_dwordx4 v36, s[28:31], s52 offen offset:2048 nt lds
    s_waitcnt vmcnt(23)
    buffer_load_dwordx4 v37, s[28:31], s52 offen offset:3072 nt lds
    s_waitcnt vmcnt(23)
    s_mov_b32 s52, 94208
    s_mov_b32 m0, s52
    s_nop 0
    buffer_load_dwordx4 v36, s[28:31], s52 offen offset:0 nt lds
    s_waitcnt vmcnt(23)
    buffer_load_dwordx4 v37, s[28:31], s52 offen offset:1024 nt lds
    s_waitcnt vmcnt(23)
    buffer_load_dwordx4 v36, s[28:31], s52 offen offset:2048 nt lds
    s_waitcnt vmcnt(23)
    v_mov_b32 v14, 72
    ds_write_b32 v2, v14 offset:20
    buffer_load_dwordx4 v37, s[28:31], s52 offen offset:3072 nt lds
    s_mov_b64 exec, 1
    s_waitcnt vmcnt(12)
    v_mov_b32 v14, 84
    ds_max_u32 v2, v14 offset:20
    s_waitcnt vmcnt(0)
    v_mov_b32 v14, 96
    ds_max_u32 v2, v14 offset:20
    s_waitcnt lgkmcnt(0)
    s_endpgm
L_POLLER:
    v_lshlrev_b32 v32, 2, v1
    v_mov_b32 v135, 0
    s_lshl_b32 s50, s45, 2
    s_add_u32 s50, s50, 128
    v_mov_b32 v33, s50
    s_mov_b32 s42, 256
    s_mov_b32 s43, 0x00020000
    s_waitcnt lgkmcnt(0)
    s_mul_i32 s50, s45, 4352
    s_add_u32 s50, s50, 0x800000
    s_add_u32 s96, s18, s50
    s_addc_u32 s97, s19, 0
    s_mov_b32 s98, 32
    s_mov_b32 s99, 0x00020000
    s_mov_b32 s40, s16
    s_mov_b32 s41, s17
    s_cmp_lg_u32 s46, 0
    s_cbranch_scc1 L_NOCLR
    buffer_store_dword v135, v32, s[96:99], 0 offen sc1
L_NOCLR:
    s_barrier
    s_barrier
    s_barrier
    s_mov_b64 exec, 1
    s_cmp_lg_u32 s46, 0
    s_cbranch_scc1 L_NOSIG
    s_waitcnt vmcnt(0)
    buffer_store_dword v3, v33, s[40:43], 0 offen sc1
L_NOSIG:
    s_barrier
    s_barrier
    s_barrier
    s_barrier
    s_barrier
    buffer_load_dword v34, v33, s[40:43], 0 offen sc1
    s_barrier
    s_barrier
    s_barrier
L_CHK:
    s_waitcnt vmcnt(0)
    v_readfirstlane_b32 s49, v34
    s_cmp_eq_u32 s49, 1
    s_cbranch_scc1 L_CHK_DONE
    s_add_u32 s64, s64, 1
    s_cmp_gt_u32 s64, 400000
    s_cbranch_scc1 L_CHK_DONE
    s_sleep 4
    buffer_load_dword v34, v33, s[40:43], 0 offen sc1
    s_branch L_CHK
L_CHK_DONE:
    s_barrier
    s_mov_b32 s64, 0
    s_mov_b32 s9, 0
    s_mov_b64 exec, 255
L_POLL:
    s_load_dwordx8 s[20:27], s[96:97], 0 glc
    s_add_u32 s64, s64, 1
    s_cmp_gt_u32 s64, 400000
    s_cselect_b32 s50, 0xff, s9
    s_cmp_lt_u32 s64, 12
    s_cbranch_scc1 L_POLL_S
    buffer_load_dword v34, v32, s[96:99], 0 offen sc1
    s_waitcnt vmcnt(0)
    v_cmp_eq_u32 vcc, 1, v34
    s_nop 1
    s_or_b32 s50, s50, vcc_lo
L_POLL_S:
    s_waitcnt lgkmcnt(0)
    s_cmp_eq_u32 s20, 1
    s_cselect_b32 s20, 1, 0
    s_or_b32 s50, s50, s20
    s_cmp_eq_u32 s21, 1
    s_cselect_b32 s21, 2, 0
    s_or_b32 s50, s50, s21
    s_cmp_eq_u32 s22, 1
    s_cselect_b32 s22, 4, 0
    s_or_b32 s50, s50, s22
    s_cmp_eq_u32 s23, 1
    s_cselect_b32 s23, 8, 0
    s_or_b32 s50, s50, s23
    s_cmp_eq_u32 s24, 1
    s_cselect_b32 s24, 16, 0
    s_or_b32 s50, s50, s24
    s_cmp_eq_u32 s25, 1
    s_cselect_b32 s25, 32, 0
    s_or_b32 s50, s50, s25
    s_cmp_eq_u32 s26, 1
    s_cselect_b32 s26, 64, 0
    s_or_b32 s50, s50, s26
    s_cmp_eq_u32 s27, 1
    s_cselect_b32 s27, 128, 0
    s_or_b32 s50, s50, s27
    s_mov_b32 s49, s50
    s_cmp_eq_u32 s49, s9
    s_cbranch_scc1 L_POLL_SAME
    v_mov_b32 v14, s49
    ds_write_b32 v2, v14 offset:8
    s_mov_b32 s9, s49
    s_cmp_eq_u32 s9, 0xff
    s_cbranch_scc1 L_POLL_DONE
L_POLL_SAME:
    s_sleep 1
    s_branch L_POLL
L_POLL_DONE:
    s_waitcnt lgkmcnt(0)
L_END:
    s_endpgm
.section .rodata,"a"
.p2align 6
.amdhsa_kernel standalone__low_rank_proj_linformer__prompt_kernel
  .amdhsa_next_free_vgpr 160
  .amdhsa_next_free_sgpr 102
  .amdhsa_accum_offset 160
  .amdhsa_group_segment_fixed_size 0
  .amdhsa_kernarg_size 64
  .amdhsa_user_sgpr_count 2
  .amdhsa_user_sgpr_kernarg_segment_ptr 1
  .amdhsa_system_sgpr_workgroup_id_x 1
.end_amdhsa_kernel
```
